```python
import torch

def _softmax(x, axis=-1):
    return torch.softmax(x, dim=axis)
def _gelu(x):
    return torch.nn.functional.gelu(x, approximate="tanh")
def _silu(x):
    return torch.nn.functional.silu(x)
def _sigmoid(x):
    return torch.sigmoid(x)
def _layernorm(x, axis=-1, eps=1e-5):
    m = x.mean(dim=axis, keepdim=True)
    v = x.var(dim=axis, keepdim=True, unbiased=False)
    return (x - m) / torch.sqrt(v + eps)
def _scatter_add(tgt, idx, src, axis=0):
    return tgt.clone().index_add_(axis, idx, src)
def _segment_sum(src, seg, n):
    out = torch.zeros((n,) + src.shape[1:], dtype=src.dtype)
    return out.index_add_(0, seg, src)
def _pad(x, pw):
    flat = tuple(v for pair in reversed(pw) for v in pair)
    return torch.nn.functional.pad(x, flat)

kernel_name = 'gated_mix__sliding_block__moe_arch_mod__prompt'

def setup_inputs():

    _w = (lambda a: (lambda t: t.to(torch.bfloat16) if t.is_floating_point() else t)(torch.as_tensor(a)))
    def _A_setup():
        B, S, D = 1, 2048, 640
        return {
            "x": _w((lambda *s: torch.randn(*s, dtype=torch.bfloat16) * 0.05)(B, S, D)),
            "wqkv": _w((lambda *s: torch.randn(*s, dtype=torch.bfloat16) * 1.6)(D, 3 * D)),
            "wo": _w((lambda *s: torch.randn(*s, dtype=torch.bfloat16) * 0.05)(D, D)),
        }
    _A_in = _A_setup()

    def _B_setup():
        B, S, D, F, C = 1, 2048, 640, 1536, 2
        return {
            "x": _w((lambda *s: torch.randn(*s, dtype=torch.bfloat16) * 0.05)(B, S, D)),
            "w_r": _w((lambda *s: torch.randn(*s, dtype=torch.bfloat16) * 3.2)(D)),
            "w_gate": _w((lambda *s: torch.randn(*s, dtype=torch.bfloat16) * 0.4)(D, F)),
            "w_up": _w((lambda *s: torch.randn(*s, dtype=torch.bfloat16) * 0.4)(D, F)),
            "w_down": _w((lambda *s: torch.randn(*s, dtype=torch.bfloat16) * 0.4)(F, D)),
        }
    _B_in = _B_setup()

    return {
        "A_x": _A_in["x"],
        "A_wqkv": _A_in["wqkv"],
        "A_wo": _A_in["wo"],
        "B_x": _B_in["x"],
        "B_w_r": _B_in["w_r"],
        "B_w_gate": _B_in["w_gate"],
        "B_w_up": _B_in["w_up"],
        "B_w_down": _B_in["w_down"],
        "gate_w": _w((lambda *s: torch.randn(*s, dtype=torch.bfloat16) * 0.05)(640) * 16.0),
    }

def reference(A_x, A_wqkv, A_wo, B_x, B_w_r, B_w_gate, B_w_up, B_w_down, gate_w):
    def _A_ref(x, wqkv, wo):
        B, S, D = x.shape
        H = 32; Dh = D // H; W = 256
        qkv = (lambda x, *d: x.permute(*d))((x @ wqkv).reshape(B, S, 3, H, Dh), 2, 0, 3, 1, 4)
        q, k, v = qkv[0], qkv[1], qkv[2]
        scores = torch.einsum("bhqd,bhkd->bhqk", q, k) * (Dh ** -0.5)
        idx = torch.arange(S)
        mask = (idx[:, None] - idx[None, :] >= 0) & (idx[:, None] - idx[None, :] < W)
        scores = torch.where(mask[None, None], scores, -1e9)
        p = _softmax(scores, axis=-1)
        o = torch.einsum("bhqk,bhkd->bhqd", p, v)
        return (lambda x, *d: x.permute(*d))(o, 0, 2, 1, 3).reshape(B, S, D) @ wo

    def _B_ref(x, w_r, w_gate, w_up, w_down):
        B, S, D = x.shape
        C = 2
        r = x @ w_r
        idx = torch.argsort(-r, axis=-1)[:, :C]
        idx_e = (lambda x, n, axis: torch.repeat_interleave(x, n, dim=axis))(idx.reshape(B, C, 1), D, axis=2)
        x_sel = (lambda x, i, axis: torch.take_along_dim(x, i, dim=axis))(x, idx_e, axis=1)
        g = _silu(x_sel @ w_gate)
        u = x_sel @ w_up
        y = (g * u) @ w_down
        r_sel = _sigmoid((lambda x, i, axis: torch.take_along_dim(x, i, dim=axis))(r, idx, axis=1))
        y = y * r_sel.reshape(B, C, 1)
        b_off = (torch.arange(B) * S).reshape(B, 1)
        flat_idx = (idx + b_off).reshape(B * C)
        zero = (x * 0.0).reshape(B * S, D)
        upd = _scatter_add(zero, flat_idx, y.reshape(B * C, D), axis=0)
        return x + upd.reshape(B, S, D)

    x = A_x
    g = _sigmoid((x * gate_w).sum(-1, keepdims=True))
    a = _A_ref(x, A_wqkv, A_wo)
    b = _B_ref(x, B_w_r, B_w_gate, B_w_up, B_w_down)
    return g * a + (1 - g) * b
```

```asm
; @launch grid=(256,1,1) block=(640,1,1) lds=163840
.amdgcn_target "amdgcn-amd-amdhsa--gfx950"
.text
.globl gated_mix__sliding_block__moe_arch_mod__prompt_kernel
.p2align 8
.type gated_mix__sliding_block__moe_arch_mod__prompt_kernel,@function
gated_mix__sliding_block__moe_arch_mod__prompt_kernel:
    s_cmp_ge_u32 s2, 256
    s_cbranch_scc1 L_exit
    s_load_dwordx4 s[4:7], s[0:1], 0
    s_load_dwordx2 s[12:13], s[0:1], 88
    v_lshrrev_b32 v2, 6, v0
    v_and_b32 v1, 63, v0
    v_readfirstlane_b32 s28, v2
    s_and_b32 s29, s2, 7
    s_lshr_b32 s30, s2, 3
    s_and_b32 s31, s30, 1
    s_lshr_b32 s32, s30, 1
    v_lshrrev_b32 v4, 4, v1
    s_cmp_lg_u32 s28, 0
    s_cbranch_scc1 L_nopf
    s_getpc_b64 s[36:37]
L_pc:
    s_and_b32 s38, s30, 3
    s_mul_i32 s38, s38, 5760
    v_min_u32 v5, 44, v1
    v_lshl_add_u32 v5, v5, 7, s38
    v_min_u32 v5, L_code_end-L_pc-4, v5
    global_load_dword v167, v5, s[36:37]
L_nopf:
    s_cmp_lt_u32 s28, 4
    s_cbranch_scc1 L_compute
    s_cmp_ge_u32 s28, 8
    s_cbranch_scc1 L_help
    v_and_b32 v2, 3, v2
    v_lshrrev_b32 v3, 3, v1
    v_lshl_add_u32 v3, v2, 3, v3
    v_mul_u32_u24 v3, 1280, v3
    v_lshl_add_u32 v5, v2, 2, v4
    v_xor_b32 v6, v5, v1
    v_and_b32 v6, 7, v6
    v_lshl_add_u32 v10, v6, 4, v3
    v_mul_u32_u24 v5, 3840, v5
    v_lshrrev_b32 v6, 1, v2
    v_lshl_add_u32 v6, v6, 2, v4
    v_lshlrev_b32 v6, 1, v6
    v_xor_b32 v6, v6, v1
    v_and_b32 v6, 15, v6
    v_lshl_add_u32 v11, v6, 4, v5
    s_lshl_b32 s34, s29, 1
    s_add_u32 s34, s34, s31
    s_mul_i32 s34, s34, 128*1280
    s_lshl_b32 s35, s32, 8
    s_and_b32 s40, s28, 3
    s_lshl_b32 s40, s40, 10
    s_add_u32 s41, s40, 49152
    s_mov_b32 s42, 0
    s_mov_b32 s18, 2621440
    s_mov_b32 s19, 0x20000
    s_mov_b32 s22, 2457600
    s_mov_b32 s23, 0x20000
    s_mov_b32 s46, 0x76543210
    s_movk_i32 s47, 0x98
    s_lshl_b32 s36, s29, 2
    s_lshr_b32 s48, 0x1234567, s36
    s_and_b32 s48, s48, 15
    s_cmp_eq_u32 s32, 15
    s_cselect_b32 s46, 0x98765432, s46
    s_cselect_b32 s47, 0x10, s47
    s_and_b32 s33, s46, 15
    s_lshr_b64 s[46:47], s[46:47], 4
    s_add_u32 s33, s33, s48
    s_sub_u32 s36, s33, 10
    s_cselect_b32 s33, s33, s36
    s_waitcnt lgkmcnt(0)
    s_mov_b32 s16, s4
    s_mov_b32 s17, s5
    s_mov_b32 s20, s6
    s_mov_b32 s21, s7
    s_add_u32 s14, s12, 17956864
    s_addc_u32 s15, s13, 0
    s_load_dword s60, s[14:15], 0
    s_cmp_eq_u32 s32, 15
    s_cbranch_scc1 L_rld
    s_branch L_ld_issue
L_ld_loop:
    s_waitcnt vmcnt(8) lgkmcnt(0)
    s_barrier
L_ld_issue:
    s_lshl_b32 s36, s33, 7
    s_add_u32 s36, s36, s34
    s_mul_i32 s37, s33, 245760
    s_add_u32 s37, s37, s35
    s_add_u32 m0, s40, 0
    s_add_u32 s38, s36, 0
    buffer_load_dwordx4 v10, s[16:19], s38 offen  lds
    s_add_u32 m0, s40, 49152
    s_add_u32 s39, s37, 0
    buffer_load_dwordx4 v11, s[20:23], s39 offen  lds
    s_add_u32 m0, s40, 4096
    s_add_u32 s38, s36, 40960
    buffer_load_dwordx4 v10, s[16:19], s38 offen  lds
    s_add_u32 m0, s40, 53248
    s_add_u32 s39, s37, 61440
    buffer_load_dwordx4 v11, s[20:23], s39 offen  lds
    s_add_u32 m0, s40, 8192
    s_add_u32 s38, s36, 81920
    buffer_load_dwordx4 v10, s[16:19], s38 offen  lds
    s_add_u32 m0, s40, 57344
    s_add_u32 s39, s37, 122880
    buffer_load_dwordx4 v11, s[20:23], s39 offen  lds
    s_add_u32 m0, s40, 12288
    s_add_u32 s38, s36, 122880
    buffer_load_dwordx4 v10, s[16:19], s38 offen  lds
    s_add_u32 m0, s40, 61440
    s_add_u32 s39, s37, 184320
    buffer_load_dwordx4 v11, s[20:23], s39 offen  lds
    s_and_b32 s33, s46, 15
    s_lshr_b64 s[46:47], s[46:47], 4
    s_add_u32 s33, s33, s48
    s_sub_u32 s36, s33, 10
    s_cselect_b32 s33, s33, s36
    s_add_u32 s40, s40, 16384
    s_cmp_eq_u32 s40, s41
    s_cselect_b32 s36, 49152, 0
    s_sub_u32 s40, s40, s36
    s_add_u32 s42, s42, 1
    s_cmp_lt_u32 s42, 2
    s_cbranch_scc1 L_ld_issue
    s_cmp_lt_u32 s42, 10
    s_cbranch_scc1 L_ld_loop
    s_mov_b32 s24, s12
    s_mov_b32 s25, s13
    s_mov_b32 s26, 19922944
    s_mov_b32 s27, 0x20000
    s_add_u32 s60, s60, 0x9e3779b9
    s_waitcnt vmcnt(8)
    s_barrier
    s_waitcnt vmcnt(0)
    s_barrier
    s_branch L_att_setup
L_compute:
    v_and_b32 v3, 15, v1
    s_and_b32 s36, s28, 1
    s_lshr_b32 s37, s28, 1
    s_lshl_b32 s38, s37, 13
    s_lshl_b32 s39, s28, 12
    s_cmp_eq_u32 s32, 15
    s_cselect_b32 s38, s39, s38
    v_lshrrev_b32 v5, 1, v3
    v_xor_b32 v5, v5, v4
    v_lshlrev_b32 v5, 4, v5
    v_lshl_add_u32 v12, v3, 7, v5
    v_add_u32 v12, s38, v12
    v_xor_b32 v13, 64, v12
    v_bfe_u32 v5, v1, 2, 2
    v_lshl_add_u32 v6, v4, 3, v5
    v_lshlrev_b32 v6, 8, v6
    v_and_b32 v7, 1, v4
    v_lshl_add_u32 v5, v7, 2, v5
    v_lshlrev_b32 v5, 1, v5
    v_and_b32 v7, 3, v1
    s_lshl_b32 s39, s36, 3
    v_add_u32 v7, s39, v7
    v_xor_b32 v5, v5, v7
    v_lshl_add_u32 v6, v5, 4, v6
    v_bfe_u32 v5, v1, 1, 1
    v_lshl_add_u32 v6, v5, 3, v6
    v_add_u32 v14, 49152, v6
    v_xor_b32 v15, 8, v14
    v_xor_b32 v16, 64, v14
    v_xor_b32 v17, 0x48, v14
    v_lshlrev_b32 v18, 4, v3
    v_lshl_add_u32 v18, v4, 12, v18
    v_mov_b32 v19, 157440
    s_mul_i32 s34, s29, 983040
    s_lshl_b32 s39, s32, 16
    s_add_u32 s34, s34, s39
    s_lshl_b32 s39, s36, 15
    s_add_u32 s34, s34, s39
    s_lshl_b32 s39, s31, 11
    s_add_u32 s34, s34, s39
    s_lshl_b32 s39, s37, 10
    s_add_u32 s34, s34, s39
    s_add_u32 s35, s34, 16384
    s_mov_b32 s42, 0
    s_mov_b32 s43, 0
    s_movk_i32 s45, 0x4000
    s_waitcnt lgkmcnt(0)
    s_add_u32 s14, s12, 17956864
    s_addc_u32 s15, s13, 0
    s_load_dword s60, s[14:15], 0
    s_mov_b32 s24, s12
    s_mov_b32 s25, s13
    s_mov_b32 s26, 19922944
    s_mov_b32 s27, 0x20000
    v_mov_b32 v32, 0
    v_mov_b32 v33, 0
    v_mov_b32 v34, 0
    v_mov_b32 v35, 0
    v_mov_b32 v36, 0
    v_mov_b32 v37, 0
    v_mov_b32 v38, 0
    v_mov_b32 v39, 0
    v_mov_b32 v40, 0
    v_mov_b32 v41, 0
    v_mov_b32 v42, 0
    v_mov_b32 v43, 0
    v_mov_b32 v44, 0
    v_mov_b32 v45, 0
    v_mov_b32 v46, 0
    v_mov_b32 v47, 0
    v_mov_b32 v48, 0
    v_mov_b32 v49, 0
    v_mov_b32 v50, 0
    v_mov_b32 v51, 0
    v_mov_b32 v52, 0
    v_mov_b32 v53, 0
    v_mov_b32 v54, 0
    v_mov_b32 v55, 0
    v_mov_b32 v56, 0
    v_mov_b32 v57, 0
    v_mov_b32 v58, 0
    v_mov_b32 v59, 0
    v_mov_b32 v60, 0
    v_mov_b32 v61, 0
    v_mov_b32 v62, 0
    v_mov_b32 v63, 0
    v_mov_b32 v64, 0
    v_mov_b32 v65, 0
    v_mov_b32 v66, 0
    v_mov_b32 v67, 0
    v_mov_b32 v68, 0
    v_mov_b32 v69, 0
    v_mov_b32 v70, 0
    v_mov_b32 v71, 0
    v_mov_b32 v72, 0
    v_mov_b32 v73, 0
    v_mov_b32 v74, 0
    v_mov_b32 v75, 0
    v_mov_b32 v76, 0
    v_mov_b32 v77, 0
    v_mov_b32 v78, 0
    v_mov_b32 v79, 0
    v_mov_b32 v80, 0
    v_mov_b32 v81, 0
    v_mov_b32 v82, 0
    v_mov_b32 v83, 0
    v_mov_b32 v84, 0
    v_mov_b32 v85, 0
    v_mov_b32 v86, 0
    v_mov_b32 v87, 0
    v_mov_b32 v88, 0
    v_mov_b32 v89, 0
    v_mov_b32 v90, 0
    v_mov_b32 v91, 0
    v_mov_b32 v92, 0
    v_mov_b32 v93, 0
    v_mov_b32 v94, 0
    v_mov_b32 v95, 0
    s_waitcnt lgkmcnt(0)
    s_add_u32 s60, s60, 0x9e3779b9
    s_cmp_eq_u32 s32, 15
    s_cbranch_scc1 L_router
    s_barrier
    ds_read_b64_tr_b16 v[96:97], v14 offset:0
    ds_read_b64_tr_b16 v[98:99], v14 offset:1024
    ds_read_b128 v[112:115], v12 offset:0
    ds_read_b128 v[116:119], v12 offset:2048
    ds_read_b128 v[120:123], v12 offset:4096
    ds_read_b128 v[124:127], v12 offset:6144
    ds_read_b64_tr_b16 v[100:101], v15 offset:0
    ds_read_b64_tr_b16 v[102:103], v15 offset:1024
    ds_read_b64_tr_b16 v[104:105], v16 offset:0
    ds_read_b64_tr_b16 v[106:107], v16 offset:1024
    ds_read_b64_tr_b16 v[108:109], v17 offset:0
    ds_read_b64_tr_b16 v[110:111], v17 offset:1024
L_g_loop:
    s_waitcnt lgkmcnt(6)
    v_mfma_f32_16x16x32_bf16 v[32:35], v[96:99], v[112:115], v[32:35]
    s_add_u32 s43, s43, 1
    s_cmp_eq_u32 s43, 3
    v_mfma_f32_16x16x32_bf16 v[36:39], v[96:99], v[116:119], v[36:39]
    s_cselect_b32 s44, 0xffff8000, s45
    v_mfma_f32_16x16x32_bf16 v[40:43], v[96:99], v[120:123], v[40:43]
    s_cselect_b32 s43, 0, s43
    s_add_u32 s42, s42, 1
    v_mfma_f32_16x16x32_bf16 v[44:47], v[96:99], v[124:127], v[44:47]
    s_waitcnt lgkmcnt(0)
    v_mfma_f32_16x16x32_bf16 v[60:63], v[100:103], v[124:127], v[60:63]
    ds_read_b64_tr_b16 v[128:129], v14 offset:8192
    s_nop 0
    v_mfma_f32_16x16x32_bf16 v[56:59], v[100:103], v[120:123], v[56:59]
    ds_read_b64_tr_b16 v[130:131], v14 offset:9216
    v_mfma_f32_16x16x32_bf16 v[52:55], v[100:103], v[116:119], v[52:55]
    ds_read_b128 v[144:147], v13 offset:0
    v_mfma_f32_16x16x32_bf16 v[48:51], v[100:103], v[112:115], v[48:51]
    ds_read_b128 v[148:151], v13 offset:2048
    v_mfma_f32_16x16x32_bf16 v[64:67], v[104:107], v[112:115], v[64:67]
    ds_read_b128 v[152:155], v13 offset:4096
    v_mfma_f32_16x16x32_bf16 v[68:71], v[104:107], v[116:119], v[68:71]
    ds_read_b128 v[156:159], v13 offset:6144
    v_mfma_f32_16x16x32_bf16 v[72:75], v[104:107], v[120:123], v[72:75]
    ds_read_b64_tr_b16 v[132:133], v15 offset:8192
    v_mfma_f32_16x16x32_bf16 v[76:79], v[104:107], v[124:127], v[76:79]
    ds_read_b64_tr_b16 v[134:135], v15 offset:9216
    v_mfma_f32_16x16x32_bf16 v[92:95], v[108:111], v[124:127], v[92:95]
    ds_read_b64_tr_b16 v[136:137], v16 offset:8192
    v_mfma_f32_16x16x32_bf16 v[88:91], v[108:111], v[120:123], v[88:91]
    ds_read_b64_tr_b16 v[138:139], v16 offset:9216
    v_mfma_f32_16x16x32_bf16 v[84:87], v[108:111], v[116:119], v[84:87]
    ds_read_b64_tr_b16 v[140:141], v17 offset:8192
    v_mfma_f32_16x16x32_bf16 v[80:83], v[108:111], v[112:115], v[80:83]
    ds_read_b64_tr_b16 v[142:143], v17 offset:9216
    s_waitcnt lgkmcnt(6)
    v_mfma_f32_16x16x32_bf16 v[32:35], v[128:131], v[144:147], v[32:35]
    v_add_u32 v12, s44, v12
    v_add_u32 v13, s44, v13
    v_mfma_f32_16x16x32_bf16 v[36:39], v[128:131], v[148:151], v[36:39]
    v_add_u32 v14, s44, v14
    v_add_u32 v15, s44, v15
    v_mfma_f32_16x16x32_bf16 v[40:43], v[128:131], v[152:155], v[40:43]
    v_add_u32 v16, s44, v16
    v_add_u32_e64 v17, s44, v17
    v_mfma_f32_16x16x32_bf16 v[44:47], v[128:131], v[156:159], v[44:47]
    s_cmp_lt_u32 s42, 9
    s_waitcnt lgkmcnt(0)
    v_mfma_f32_16x16x32_bf16 v[60:63], v[132:135], v[156:159], v[60:63]
    v_mfma_f32_16x16x32_bf16 v[56:59], v[132:135], v[152:155], v[56:59]
    v_mfma_f32_16x16x32_bf16 v[52:55], v[132:135], v[148:151], v[52:55]
    v_mfma_f32_16x16x32_bf16 v[48:51], v[132:135], v[144:147], v[48:51]
    s_barrier
    s_nop 0
    v_mfma_f32_16x16x32_bf16 v[64:67], v[136:139], v[144:147], v[64:67]
    ds_read_b64_tr_b16 v[96:97], v14 offset:0
    ds_read_b64_tr_b16 v[98:99], v14 offset:1024
    v_mfma_f32_16x16x32_bf16 v[68:71], v[136:139], v[148:151], v[68:71]
    ds_read_b128 v[112:115], v12 offset:0
    ds_read_b128 v[116:119], v12 offset:2048
    v_mfma_f32_16x16x32_bf16 v[72:75], v[136:139], v[152:155], v[72:75]
    ds_read_b128 v[120:123], v12 offset:4096
    ds_read_b128 v[124:127], v12 offset:6144
    v_mfma_f32_16x16x32_bf16 v[76:79], v[136:139], v[156:159], v[76:79]
    ds_read_b64_tr_b16 v[100:101], v15 offset:0
    ds_read_b64_tr_b16 v[102:103], v15 offset:1024
    v_mfma_f32_16x16x32_bf16 v[92:95], v[140:143], v[156:159], v[92:95]
    ds_read_b64_tr_b16 v[104:105], v16 offset:0
    v_mfma_f32_16x16x32_bf16 v[88:91], v[140:143], v[152:155], v[88:91]
    ds_read_b64_tr_b16 v[106:107], v16 offset:1024
    v_mfma_f32_16x16x32_bf16 v[84:87], v[140:143], v[148:151], v[84:87]
    ds_read_b64_tr_b16 v[108:109], v17 offset:0
    v_mfma_f32_16x16x32_bf16 v[80:83], v[140:143], v[144:147], v[80:83]
    ds_read_b64_tr_b16 v[110:111], v17 offset:1024
    s_cbranch_scc1 L_g_loop
    s_waitcnt lgkmcnt(4)
    v_mfma_f32_16x16x32_bf16 v[32:35], v[96:99], v[112:115], v[32:35]
    ds_read_b32 v20, v19
    ds_read_b64_tr_b16 v[128:129], v14 offset:8192
    v_mfma_f32_16x16x32_bf16 v[36:39], v[96:99], v[116:119], v[36:39]
    ds_read_b64_tr_b16 v[130:131], v14 offset:9216
    ds_read_b128 v[144:147], v13 offset:0
    v_mfma_f32_16x16x32_bf16 v[40:43], v[96:99], v[120:123], v[40:43]
    ds_read_b64_tr_b16 v[132:133], v15 offset:8192
    ds_read_b64_tr_b16 v[134:135], v15 offset:9216
    v_mfma_f32_16x16x32_bf16 v[44:47], v[96:99], v[124:127], v[44:47]
    ds_read_b128 v[148:151], v13 offset:2048
    ds_read_b128 v[152:155], v13 offset:4096
    v_mfma_f32_16x16x32_bf16 v[60:63], v[100:103], v[124:127], v[60:63]
    ds_read_b128 v[156:159], v13 offset:6144
    ds_read_b64_tr_b16 v[136:137], v16 offset:8192
    v_mfma_f32_16x16x32_bf16 v[56:59], v[100:103], v[120:123], v[56:59]
    ds_read_b64_tr_b16 v[138:139], v16 offset:9216
    ds_read_b64_tr_b16 v[140:141], v17 offset:8192
    v_mfma_f32_16x16x32_bf16 v[52:55], v[100:103], v[116:119], v[52:55]
    ds_read_b64_tr_b16 v[142:143], v17 offset:9216
    v_mfma_f32_16x16x32_bf16 v[48:51], v[100:103], v[112:115], v[48:51]
    s_mov_b32 s38, 0x3ea52b5c
    s_mov_b32 s39, s38
    s_waitcnt lgkmcnt(4)
    v_readfirstlane_b32 s61, v20
    s_cmp_lt_u32 s32, 5
    s_cbranch_scc1 L_g_q
    v_mfma_f32_16x16x32_bf16 v[32:35], v[128:131], v[144:147], v[32:35]
    v_mfma_f32_16x16x32_bf16 v[48:51], v[132:135], v[144:147], v[48:51]
    s_nop 1
    v_mfma_f32_16x16x32_bf16 v[64:67], v[104:107], v[112:115], v[64:67]
    s_nop 1
    v_mfma_f32_16x16x32_bf16 v[80:83], v[108:111], v[112:115], v[80:83]
    s_nop 1
    v_mfma_f32_16x16x32_bf16 v[36:39], v[128:131], v[148:151], v[36:39]
    v_cvt_pk_bf16_f32 v32, v32, v33
    v_cvt_pk_bf16_f32 v33, v34, v35
    v_mfma_f32_16x16x32_bf16 v[52:55], v[132:135], v[148:151], v[52:55]
    v_cvt_pk_bf16_f32 v34, v48, v49
    v_cvt_pk_bf16_f32 v35, v50, v51
    v_mfma_f32_16x16x32_bf16 v[68:71], v[104:107], v[116:119], v[68:71]
    buffer_store_dwordx4 v[32:35], v18, s[24:27], s34 offen offset:0 sc1
    v_mfma_f32_16x16x32_bf16 v[84:87], v[108:111], v[116:119], v[84:87]
    s_nop 1
    v_mfma_f32_16x16x32_bf16 v[40:43], v[128:131], v[152:155], v[40:43]
    v_cvt_pk_bf16_f32 v36, v36, v37
    v_cvt_pk_bf16_f32 v37, v38, v39
    s_nop 0
    v_mfma_f32_16x16x32_bf16 v[56:59], v[132:135], v[152:155], v[56:59]
    v_cvt_pk_bf16_f32 v38, v52, v53
    v_cvt_pk_bf16_f32 v39, v54, v55
    v_mfma_f32_16x16x32_bf16 v[72:75], v[104:107], v[120:123], v[72:75]
    buffer_store_dwordx4 v[36:39], v18, s[24:27], s34 offen offset:256 sc1
    v_mfma_f32_16x16x32_bf16 v[88:91], v[108:111], v[120:123], v[88:91]
    s_nop 1
    v_mfma_f32_16x16x32_bf16 v[44:47], v[128:131], v[156:159], v[44:47]
    s_nop 0
    v_cvt_pk_bf16_f32 v40, v40, v41
    v_cvt_pk_bf16_f32 v41, v42, v43
    v_mfma_f32_16x16x32_bf16 v[60:63], v[132:135], v[156:159], v[60:63]
    v_cvt_pk_bf16_f32 v42, v56, v57
    v_cvt_pk_bf16_f32 v43, v58, v59
    v_mfma_f32_16x16x32_bf16 v[76:79], v[104:107], v[124:127], v[76:79]
    buffer_store_dwordx4 v[40:43], v18, s[24:27], s34 offen offset:512 sc1
    v_mfma_f32_16x16x32_bf16 v[92:95], v[108:111], v[124:127], v[92:95]
    s_nop 1
    s_waitcnt lgkmcnt(0)
    v_mfma_f32_16x16x32_bf16 v[64:67], v[136:139], v[144:147], v[64:67]
    v_cvt_pk_bf16_f32 v44, v44, v45
    v_cvt_pk_bf16_f32 v45, v46, v47
    v_mfma_f32_16x16x32_bf16 v[80:83], v[140:143], v[144:147], v[80:83]
    v_cvt_pk_bf16_f32 v46, v60, v61
    v_cvt_pk_bf16_f32 v47, v62, v63
    v_mfma_f32_16x16x32_bf16 v[68:71], v[136:139], v[148:151], v[68:71]
    buffer_store_dwordx4 v[44:47], v18, s[24:27], s34 offen offset:768 sc1
    v_mfma_f32_16x16x32_bf16 v[84:87], v[140:143], v[148:151], v[84:87]
    s_nop 1
    v_mfma_f32_16x16x32_bf16 v[72:75], v[136:139], v[152:155], v[72:75]
    s_nop 0
    v_cvt_pk_bf16_f32 v64, v64, v65
    v_cvt_pk_bf16_f32 v65, v66, v67
    v_mfma_f32_16x16x32_bf16 v[88:91], v[140:143], v[152:155], v[88:91]
    v_cvt_pk_bf16_f32 v66, v80, v81
    v_cvt_pk_bf16_f32 v67, v82, v83
    v_mfma_f32_16x16x32_bf16 v[76:79], v[136:139], v[156:159], v[76:79]
    buffer_store_dwordx4 v[64:67], v18, s[24:27], s35 offen offset:0 sc1
    v_cvt_pk_bf16_f32 v68, v68, v69
    v_mfma_f32_16x16x32_bf16 v[92:95], v[140:143], v[156:159], v[92:95]
    v_cvt_pk_bf16_f32 v69, v70, v71
    v_cvt_pk_bf16_f32 v70, v84, v85
    v_cvt_pk_bf16_f32 v71, v86, v87
    buffer_store_dwordx4 v[68:71], v18, s[24:27], s35 offen offset:256 sc1
    v_cvt_pk_bf16_f32 v72, v72, v73
    v_cvt_pk_bf16_f32 v73, v74, v75
    v_cvt_pk_bf16_f32 v74, v88, v89
    v_cvt_pk_bf16_f32 v75, v90, v91
    buffer_store_dwordx4 v[72:75], v18, s[24:27], s35 offen offset:512 sc1
    v_cvt_pk_bf16_f32 v76, v76, v77
    v_cvt_pk_bf16_f32 v77, v78, v79
    v_cvt_pk_bf16_f32 v78, v92, v93
    v_cvt_pk_bf16_f32 v79, v94, v95
    buffer_store_dwordx4 v[76:79], v18, s[24:27], s35 offen offset:768 sc1
L_g_end:
L_pubflag:
    s_lshl_b32 s36, s29, 4
    s_add_u32 s36, s36, s32
    s_lshl_b32 s36, s36, 1
    s_and_b32 s37, s28, 1
    s_add_u32 s36, s36, s37
    s_lshl_b32 s40, s36, 7
    s_lshl_b32 s36, s36, 4
    s_lshl_b32 s37, s31, 3
    s_and_b32 s38, s28, 2
    s_lshl_b32 s38, s38, 1
    s_add_u32 s37, s37, s38
    s_add_u32 s36, s36, s37
    s_add_u32 s56, s36, 16973824
    s_add_u32 s40, s40, s37
    s_add_u32 s57, s40, 17006592
    s_mov_b32 s58, 1
    s_branch L_att_setup1
L_g_q:
    s_cmp_eq_u32 s61, 0
    s_cbranch_scc1 L_q_far
    v_mfma_f32_16x16x32_bf16 v[32:35], v[128:131], v[144:147], v[32:35]
    v_mfma_f32_16x16x32_bf16 v[48:51], v[132:135], v[144:147], v[48:51]
    s_nop 1
    v_mfma_f32_16x16x32_bf16 v[64:67], v[104:107], v[112:115], v[64:67]
    s_nop 1
    v_mfma_f32_16x16x32_bf16 v[80:83], v[108:111], v[112:115], v[80:83]
    s_nop 1
    v_mfma_f32_16x16x32_bf16 v[36:39], v[128:131], v[148:151], v[36:39]
    v_pk_mul_f32 v[32:33], v[32:33], s[38:39]
    v_pk_mul_f32 v[34:35], v[34:35], s[38:39]
    v_pk_mul_f32 v[48:49], v[48:49], s[38:39]
    v_mfma_f32_16x16x32_bf16 v[52:55], v[132:135], v[148:151], v[52:55]
    v_pk_mul_f32 v[50:51], v[50:51], s[38:39]
    v_cvt_pk_bf16_f32 v32, v32, v33
    v_cvt_pk_bf16_f32 v33, v34, v35
    v_mfma_f32_16x16x32_bf16 v[68:71], v[104:107], v[116:119], v[68:71]
    v_cvt_pk_bf16_f32 v34, v48, v49
    v_cvt_pk_bf16_f32 v35, v50, v51
    buffer_store_dwordx4 v[32:35], v18, s[24:27], s34 offen offset:0
    v_mfma_f32_16x16x32_bf16 v[84:87], v[108:111], v[116:119], v[84:87]
    v_pk_mul_f32 v[36:37], v[36:37], s[38:39]
    v_pk_mul_f32 v[38:39], v[38:39], s[38:39]
    v_pk_mul_f32 v[52:53], v[52:53], s[38:39]
    v_mfma_f32_16x16x32_bf16 v[40:43], v[128:131], v[152:155], v[40:43]
    v_pk_mul_f32 v[54:55], v[54:55], s[38:39]
    v_cvt_pk_bf16_f32 v36, v36, v37
    v_cvt_pk_bf16_f32 v37, v38, v39
    v_mfma_f32_16x16x32_bf16 v[56:59], v[132:135], v[152:155], v[56:59]
    v_cvt_pk_bf16_f32 v38, v52, v53
    v_cvt_pk_bf16_f32 v39, v54, v55
    buffer_store_dwordx4 v[36:39], v18, s[24:27], s34 offen offset:256
    v_mfma_f32_16x16x32_bf16 v[72:75], v[104:107], v[120:123], v[72:75]
    s_nop 1
    v_mfma_f32_16x16x32_bf16 v[88:91], v[108:111], v[120:123], v[88:91]
    s_nop 0
    v_mfma_f32_16x16x32_bf16 v[44:47], v[128:131], v[156:159], v[44:47]
    v_pk_mul_f32 v[40:41], v[40:41], s[38:39]
    v_pk_mul_f32 v[42:43], v[42:43], s[38:39]
    v_pk_mul_f32 v[56:57], v[56:57], s[38:39]
    v_mfma_f32_16x16x32_bf16 v[60:63], v[132:135], v[156:159], v[60:63]
    v_pk_mul_f32 v[58:59], v[58:59], s[38:39]
    v_cvt_pk_bf16_f32 v40, v40, v41
    v_cvt_pk_bf16_f32 v41, v42, v43
    v_mfma_f32_16x16x32_bf16 v[76:79], v[104:107], v[124:127], v[76:79]
    v_cvt_pk_bf16_f32 v42, v56, v57
    v_cvt_pk_bf16_f32 v43, v58, v59
    buffer_store_dwordx4 v[40:43], v18, s[24:27], s34 offen offset:512
    v_mfma_f32_16x16x32_bf16 v[92:95], v[108:111], v[124:127], v[92:95]
    v_pk_mul_f32 v[44:45], v[44:45], s[38:39]
    v_pk_mul_f32 v[46:47], v[46:47], s[38:39]
    v_pk_mul_f32 v[60:61], v[60:61], s[38:39]
    s_waitcnt lgkmcnt(0)
    v_mfma_f32_16x16x32_bf16 v[64:67], v[136:139], v[144:147], v[64:67]
    s_nop 0
    v_pk_mul_f32 v[62:63], v[62:63], s[38:39]
    v_cvt_pk_bf16_f32 v44, v44, v45
    v_cvt_pk_bf16_f32 v45, v46, v47
    v_mfma_f32_16x16x32_bf16 v[80:83], v[140:143], v[144:147], v[80:83]
    v_cvt_pk_bf16_f32 v46, v60, v61
    v_cvt_pk_bf16_f32 v47, v62, v63
    buffer_store_dwordx4 v[44:47], v18, s[24:27], s34 offen offset:768
    v_mfma_f32_16x16x32_bf16 v[68:71], v[136:139], v[148:151], v[68:71]
    s_nop 1
    v_mfma_f32_16x16x32_bf16 v[84:87], v[140:143], v[148:151], v[84:87]
    s_nop 0
    v_mfma_f32_16x16x32_bf16 v[72:75], v[136:139], v[152:155], v[72:75]
    v_pk_mul_f32 v[64:65], v[64:65], s[38:39]
    v_pk_mul_f32 v[66:67], v[66:67], s[38:39]
    v_pk_mul_f32 v[80:81], v[80:81], s[38:39]
    v_mfma_f32_16x16x32_bf16 v[88:91], v[140:143], v[152:155], v[88:91]
    v_pk_mul_f32 v[82:83], v[82:83], s[38:39]
    v_cvt_pk_bf16_f32 v64, v64, v65
    v_cvt_pk_bf16_f32 v65, v66, v67
    v_mfma_f32_16x16x32_bf16 v[76:79], v[136:139], v[156:159], v[76:79]
    v_cvt_pk_bf16_f32 v66, v80, v81
    v_cvt_pk_bf16_f32 v67, v82, v83
    buffer_store_dwordx4 v[64:67], v18, s[24:27], s35 offen offset:0
    v_mfma_f32_16x16x32_bf16 v[92:95], v[140:143], v[156:159], v[92:95]
    v_pk_mul_f32 v[68:69], v[68:69], s[38:39]
    v_pk_mul_f32 v[70:71], v[70:71], s[38:39]
    v_pk_mul_f32 v[84:85], v[84:85], s[38:39]
    v_pk_mul_f32 v[86:87], v[86:87], s[38:39]
    v_cvt_pk_bf16_f32 v68, v68, v69
    v_cvt_pk_bf16_f32 v69, v70, v71
    v_cvt_pk_bf16_f32 v70, v84, v85
    v_cvt_pk_bf16_f32 v71, v86, v87
    buffer_store_dwordx4 v[68:71], v18, s[24:27], s35 offen offset:256
    v_pk_mul_f32 v[72:73], v[72:73], s[38:39]
    v_pk_mul_f32 v[74:75], v[74:75], s[38:39]
    v_pk_mul_f32 v[88:89], v[88:89], s[38:39]
    v_pk_mul_f32 v[90:91], v[90:91], s[38:39]
    v_cvt_pk_bf16_f32 v72, v72, v73
    v_cvt_pk_bf16_f32 v73, v74, v75
    v_cvt_pk_bf16_f32 v74, v88, v89
    v_cvt_pk_bf16_f32 v75, v90, v91
    buffer_store_dwordx4 v[72:75], v18, s[24:27], s35 offen offset:512
    v_pk_mul_f32 v[76:77], v[76:77], s[38:39]
    v_pk_mul_f32 v[78:79], v[78:79], s[38:39]
    v_pk_mul_f32 v[92:93], v[92:93], s[38:39]
    v_pk_mul_f32 v[94:95], v[94:95], s[38:39]
    v_cvt_pk_bf16_f32 v76, v76, v77
    v_cvt_pk_bf16_f32 v77, v78, v79
    v_cvt_pk_bf16_f32 v78, v92, v93
    v_cvt_pk_bf16_f32 v79, v94, v95
    buffer_store_dwordx4 v[76:79], v18, s[24:27], s35 offen offset:768
    s_branch L_g_end
L_att_setup:
    s_mov_b32 s58, 0
L_att_setup1:
    s_load_dwordx2 s[52:53], s[0:1], 72
    s_mov_b32 s54, 2621440
    s_mov_b32 s55, 0x20000
    s_and_b32 s31, s30, 1
    s_mul_i32 s40, s30, 5
    s_lshr_b32 s40, s40, 1
    s_sub_u32 s33, 11, s28
    s_cmp_lt_u32 s28, 4
    s_cselect_b32 s33, s28, s33
    s_add_u32 s36, s33, 1
    s_cmp_eq_u32 s29, 0
    s_cselect_b32 s34, s36, 9
    s_cselect_b32 s36, 4, 17
    s_movk_i32 s37, 0xff
    s_cselect_b32 s37, 0x3ff, s37
    s_lshl_b32 s36, s36, s33
    s_and_b32 s35, s36, s37
    s_lshr_b32 s36, s30, 2
    s_xor_b32 s36, s36, s31
    s_andn2_b32 s41, 1, s36
    s_lshl_b32 s41, s41, 3
    s_xor_b32 s42, s31, 1
    s_lshl_b32 s42, s42, 1
    s_mul_i32 s36, s29, 240
    s_add_u32 s36, s36, s40
    s_lshl_b32 s43, s36, 12
    s_lshl_b32 s37, s33, 9
    s_add_u32 s36, s43, s37
    s_lshl_b32 s38, s31, 12
    s_add_u32 s46, s36, s38
    s_lshl_b32 s38, s42, 12
    s_add_u32 s38, s38, s41
    s_add_u32 s47, s36, s38
    v_lshlrev_b32 v10, 4, v1
    v_and_b32 v3, 31, v1
    v_lshrrev_b32 v4, 5, v1
    v_lshlrev_b32 v5, 4, v3
    v_lshl_add_u32 v15, v4, 12, v5
    v_lshl_add_u32 v16, v4, 28, v5
    s_mul_i32 s38, s31, 8256
    s_add_u32 s38, s38, s37
    v_mul_u32_u24 v6, 8256, v4
    v_add3_u32 v12, v6, v5, s38
    s_mul_i32 s38, s42, 8256
    s_add_u32 s38, s38, s41
    s_add_u32 s38, s38, s37
    v_add_u32 v6, s38, v5
    v_mov_b32 v9, 152256
    v_cmp_eq_u32 s[44:45], 0, v4
    v_bfe_u32 v7, v1, 4, 1
    v_and_b32 v8, 3, v1
    v_add_u32 v11, 8, v9
    v_cndmask_b32_e64 v13, v11, v6, s[44:45]
    v_lshl_add_u32 v6, v7, 2, v8
    v_add_u32 v7, s31, v6
    v_lshrrev_b32 v8, 1, v7
    v_add_u32 v11, s40, v8
    v_lshrrev_b32 v11, 1, v11
    v_xor_b32 v7, v7, v11
    v_and_b32 v7, 1, v7
    v_mul_u32_u24 v8, 8256, v8
    v_lshl_add_u32 v8, v7, 3, v8
    s_add_u32 s38, s37, 24832
    v_add_u32 v8, s38, v8
    v_cmp_gt_u32 s[44:45], 5, v6
    v_bfe_u32 v7, v1, 2, 2
    v_lshl_add_u32 v7, v4, 2, v7
    v_cndmask_b32_e64 v8, v9, v8, s[44:45]
    v_lshl_add_u32 v14, v7, 4, v8
    v_lshlrev_b32 v6, 2, v4
    v_sub_u32 v6, v3, v6
    v_mov_b32 v7, 0xff800000
    v_cmp_le_i32 s[44:45], 0, v6
    v_cmp_le_i32 s[48:49], 1, v6
    s_nop 0
    v_cndmask_b32_e64 v64, v7, 0, s[44:45]
    v_cndmask_b32_e64 v65, v7, 0, s[48:49]
    v_cndmask_b32_e64 v112, 0, v7, s[44:45]
    v_cndmask_b32_e64 v113, 0, v7, s[48:49]
    v_cmp_le_i32 s[44:45], 2, v6
    v_cmp_le_i32 s[48:49], 3, v6
    s_nop 0
    v_cndmask_b32_e64 v66, v7, 0, s[44:45]
    v_cndmask_b32_e64 v67, v7, 0, s[48:49]
    v_cndmask_b32_e64 v114, 0, v7, s[44:45]
    v_cndmask_b32_e64 v115, 0, v7, s[48:49]
    v_cmp_le_i32 s[44:45], 8, v6
    v_cmp_le_i32 s[48:49], 9, v6
    s_nop 0
    v_cndmask_b32_e64 v68, v7, 0, s[44:45]
    v_cndmask_b32_e64 v69, v7, 0, s[48:49]
    v_cndmask_b32_e64 v116, 0, v7, s[44:45]
    v_cndmask_b32_e64 v117, 0, v7, s[48:49]
    v_cmp_le_i32 s[44:45], 10, v6
    v_cmp_le_i32 s[48:49], 11, v6
    s_nop 0
    v_cndmask_b32_e64 v70, v7, 0, s[44:45]
    v_cndmask_b32_e64 v71, v7, 0, s[48:49]
    v_cndmask_b32_e64 v118, 0, v7, s[44:45]
    v_cndmask_b32_e64 v119, 0, v7, s[48:49]
    v_cmp_le_i32 s[44:45], 16, v6
    v_cmp_le_i32 s[48:49], 17, v6
    s_nop 0
    v_cndmask_b32_e64 v72, v7, 0, s[44:45]
    v_cndmask_b32_e64 v73, v7, 0, s[48:49]
    v_cndmask_b32_e64 v120, 0, v7, s[44:45]
    v_cndmask_b32_e64 v121, 0, v7, s[48:49]
    v_cmp_le_i32 s[44:45], 18, v6
    v_cmp_le_i32 s[48:49], 19, v6
    s_nop 0
    v_cndmask_b32_e64 v74, v7, 0, s[44:45]
    v_cndmask_b32_e64 v75, v7, 0, s[48:49]
    v_cndmask_b32_e64 v122, 0, v7, s[44:45]
    v_cndmask_b32_e64 v123, 0, v7, s[48:49]
    v_cmp_le_i32 s[44:45], 24, v6
    v_cmp_le_i32 s[48:49], 25, v6
    s_nop 0
    v_cndmask_b32_e64 v76, v7, 0, s[44:45]
    v_cndmask_b32_e64 v77, v7, 0, s[48:49]
    v_cndmask_b32_e64 v124, 0, v7, s[44:45]
    v_cndmask_b32_e64 v125, 0, v7, s[48:49]
    v_cmp_le_i32 s[44:45], 26, v6
    v_cmp_le_i32 s[48:49], 27, v6
    s_nop 0
    v_cndmask_b32_e64 v78, v7, 0, s[44:45]
    v_cndmask_b32_e64 v79, v7, 0, s[48:49]
    v_cndmask_b32_e64 v126, 0, v7, s[44:45]
    v_cndmask_b32_e64 v127, 0, v7, s[48:49]
    s_lshr_b32 s36, s28, 2
    s_mul_i32 s37, s36, 24832
    s_add_u32 s36, s36, 1
    s_mul_i32 s36, s36, 327680
    s_add_u32 s36, s36, s43
    s_and_b32 s38, s28, 3
    s_mul_i32 s38, s38, 3
    v_and_b32 v5, 15, v1
    v_mul_u32_u24 v6, 160, v5
    v_lshrrev_b32 v7, 4, v1
    v_lshl_add_u32 v6, v7, 3, v6
    s_and_b32 s39, s28, 3
    s_mul_i32 s44, s39, 2560
    v_add_u32 v19, s44, v6
    s_and_b32 s44, s30, 3
    s_lshl_b32 s44, s44, 5
    s_lshl_b32 s45, s29, 8
    s_add_u32 s48, s44, s45
    s_and_b32 s44, s39, 1
    s_lshl_b32 s44, s44, 4
    s_add_u32 s51, s48, s44
    s_and_b32 s44, s39, 2
    s_lshl_b32 s44, s44, 6
    s_add_u32 s51, s51, s44
    s_lshl_b32 s39, s33, 5
    s_add_u32 s39, s39, s45
    v_add_lshl_u32 v6, s39, v3, 2
    v_add_lshl_u32 v7, s51, v5, 2
    s_mov_b32 s39, 16777216
    v_add_u32 v11, 140800, v19
    v_mov_b32 v30, 157440
    v_mov_b32 v2, 1
    v_mov_b32 v163, s60
    s_mov_b32 s40, 0
    ds_read_b64 v[20:21], v11 offset:0
    ds_read_b64 v[22:23], v11 offset:32
    ds_read_b64 v[24:25], v11 offset:64
    ds_read_b64 v[26:27], v11 offset:96
    ds_read_b64 v[28:29], v11 offset:128
    s_add_u32 s44, s38, 0
    s_lshr_b32 s45, s44, 2
    s_mul_i32 s45, s45, 4160
    s_lshl_b32 s44, s44, 10
    s_add_u32 s45, s45, s44
    s_add_u32 s45, s45, s37
    s_add_u32 s4, s45, 4096
    s_add_u32 s5, s44, s36
    s_add_u32 s44, s38, 1
    s_lshr_b32 s45, s44, 2
    s_mul_i32 s45, s45, 4160
    s_lshl_b32 s44, s44, 10
    s_add_u32 s45, s45, s44
    s_add_u32 s45, s45, s37
    s_add_u32 s6, s45, 4096
    s_add_u32 s7, s44, s36
    s_add_u32 s44, s38, 2
    s_lshr_b32 s45, s44, 2
    s_mul_i32 s45, s45, 4160
    s_lshl_b32 s44, s44, 10
    s_add_u32 s45, s45, s44
    s_add_u32 s45, s45, s37
    s_add_u32 s8, s45, 4096
    s_add_u32 s9, s44, s36
    s_mov_b32 m0, s4
    s_cmp_eq_u32 s58, 0
    s_cbranch_scc1 L_nopub
    s_mov_b64 exec, 1
    s_waitcnt vmcnt(0)
    s_cmp_eq_u32 s61, 0
    s_cbranch_scc1 L_imp1
    buffer_store_dword v163, off, s[24:27], s56
    s_branch L_ime2
L_imp1:
    buffer_store_dword v163, off, s[24:27], s56 sc1
L_ime2:
    s_cmp_lt_u32 s32, 5
    s_cbranch_scc1 L_norf
    buffer_store_dword v163, off, s[24:27], s57 sc1
L_norf:
    ds_add_u32 v30, v2 offset:40
    s_mov_b64 exec, -1
L_nopub:
    s_waitcnt lgkmcnt(0)
    s_barrier
    buffer_load_dwordx4 v10, s[24:27], s5 offen sc1 lds
    s_mov_b32 m0, s6
    buffer_load_dword v18, v7, s[24:27], s39 offen sc1
    buffer_load_dwordx4 v10, s[24:27], s7 offen sc1 lds
    s_mov_b32 m0, s8
    buffer_load_dwordx4 v[32:35], v15, s[24:27], s46 offen sc1
    buffer_load_dwordx4 v10, s[24:27], s9 offen sc1 lds
    buffer_load_dwordx2 v[36:37], v16, s[24:27], s47 offen sc1
    buffer_load_dword v17, v6, s[24:27], s39 offen sc1
    v_and_b32 v164, 15, v1
    v_lshrrev_b32 v165, 4, v1
    v_lshrrev_b32 v5, 1, v165
    v_add_u32 v6, v165, v5
    v_lshlrev_b32 v7, 4, v164
    v_lshl_add_u32 v148, v6, 12, v7
    v_and_b32 v6, 1, v165
    v_lshl_add_u32 v8, v6, 1, v5
    v_mul_u32_u24 v9, 20480, v8
    v_add_u32 v149, v9, v7
    v_add_u32 v150, 49664, v10
    v_add_u32 v151, 100864, v10
    v_lshlrev_b32 v128, 16, v20
    v_and_b32 v129, 0xffff0000, v20
    v_lshlrev_b32 v130, 16, v21
    v_and_b32 v131, 0xffff0000, v21
    v_lshlrev_b32 v132, 16, v22
    v_and_b32 v133, 0xffff0000, v22
    v_lshlrev_b32 v134, 16, v23
    v_and_b32 v135, 0xffff0000, v23
    v_lshlrev_b32 v136, 16, v24
    v_and_b32 v137, 0xffff0000, v24
    v_lshlrev_b32 v138, 16, v25
    v_and_b32 v139, 0xffff0000, v25
    v_lshlrev_b32 v140, 16, v26
    v_and_b32 v141, 0xffff0000, v26
    v_lshlrev_b32 v142, 16, v27
    v_and_b32 v143, 0xffff0000, v27
    v_lshlrev_b32 v144, 16, v28
    v_and_b32 v145, 0xffff0000, v28
    v_lshlrev_b32 v146, 16, v29
    v_and_b32 v147, 0xffff0000, v29
    v_add_u32 v5, 0, v1
    v_mul_u32_u24 v6, 6554, v5
    v_lshrrev_b32 v6, 16, v6
    v_mul_u32_u24 v7, 10, v6
    v_sub_u32 v7, v5, v7
    v_mul_u32_u24 v6, 1280, v6
    v_lshl_add_u32 v156, v7, 4, v6
    v_add_u32 v5, 64, v1
    v_mul_u32_u24 v6, 6554, v5
    v_lshrrev_b32 v6, 16, v6
    v_mul_u32_u24 v7, 10, v6
    v_sub_u32 v7, v5, v7
    v_mul_u32_u24 v6, 1280, v6
    v_lshl_add_u32 v157, v7, 4, v6
    v_add_u32 v5, 128, v1
    v_mul_u32_u24 v6, 6554, v5
    v_lshrrev_b32 v6, 16, v6
    v_mul_u32_u24 v7, 10, v6
    v_sub_u32 v7, v5, v7
    v_mul_u32_u24 v6, 1280, v6
    v_lshl_add_u32 v158, v7, 4, v6
    v_lshl_add_u32 v158, v4, 28, v158
    s_mul_i32 s36, s28, 2560
    v_add_u32 v159, s36, v10
    v_lshlrev_b32 v160, 2, v3
    v_lshl_add_u32 v161, v165, 4, v30
    v_add_u32 v162, s51, v164
    s_mul_i32 s56, s51, 1280
    s_lshr_b32 s37, s30, 2
    s_mul_i32 s37, s37, 160
    s_add_u32 s56, s56, s37
    s_lshr_b32 s57, s51, 5
    s_lshl_b32 s57, s57, 7
    s_add_u32 s57, s57, 17104896
    s_mul_i32 s58, s29, 983040
    s_and_b32 s38, s51, 255
    s_lshl_b32 s38, s38, 4
    s_add_u32 s58, s58, s38
    s_add_u32 s59, s58, 8192
    s_waitcnt vmcnt(5)
    v_sub_f32 v18, 1.0, v18
    v_mul_f32 v128, v18, v128
    v_mul_f32 v129, v18, v129
    v_mul_f32 v130, v18, v130
    v_mul_f32 v131, v18, v131
    v_mul_f32 v132, v18, v132
    v_mul_f32 v133, v18, v133
    v_mul_f32 v134, v18, v134
    v_mul_f32 v135, v18, v135
    v_mul_f32 v136, v18, v136
    v_mul_f32 v137, v18, v137
    v_mul_f32 v138, v18, v138
    v_mul_f32 v139, v18, v139
    v_mul_f32 v140, v18, v140
    v_mul_f32 v141, v18, v141
    v_mul_f32 v142, v18, v142
    v_mul_f32 v143, v18, v143
    v_mul_f32 v144, v18, v144
    v_mul_f32 v145, v18, v145
    v_mul_f32 v146, v18, v146
    v_mul_f32 v147, v18, v147
L_noopset:
    s_waitcnt vmcnt(0)
    ds_read_b32 v31, v30
    v_mov_b32 v9, 1
    s_mov_b64 exec, 1
    ds_add_u32 v30, v9 offset:44
    s_mov_b64 exec, -1
    s_mov_b32 s50, 262144
L_lw3:
    ds_read_b32 v9, v30 offset:44
    s_sub_u32 s50, s50, 1
    s_cbranch_scc1 L_lo4
    s_waitcnt lgkmcnt(0)
    v_cmp_gt_u32 vcc, 8, v9
    s_cbranch_vccnz L_lw3
L_lo4:
    s_setprio 2
L_att_go:
    ds_read_b128 v[40:43], v12 offset:4096
    ds_read_b64 v[38:39], v13 offset:4096
    ds_read_b64_tr_b16 v[44:45], v14 offset:4096
    s_nop 0
    ds_read_b64_tr_b16 v[46:47], v14 offset:4224
    s_bitcmp1_b32 s35, 0
    s_cbranch_scc1 L_hw0
L_hr0:
    s_waitcnt lgkmcnt(2)
    v_mfma_f32_32x32x16_bf16 v[64:79], v[40:43], v[32:35], v[64:79]
    s_nop 0
    ds_read_b128 v[40:43], v12 offset:3584
    v_mfma_f32_32x32x8_bf16 v[64:79], v[38:39], v[36:37], v[64:79]
    ds_read_b64 v[38:39], v13 offset:3584
    v_readfirstlane_b32 s61, v31
    s_nop 4
    s_waitcnt lgkmcnt(0)
    s_bitcmp1_b32 s35, 1
    s_cbranch_scc1 L_hw1
L_hr1:
    v_mfma_f32_32x32x16_bf16 v[80:95], v[40:43], v[32:35], 0
    ds_read_b128 v[40:43], v12 offset:3072
    v_exp_f32 v64, v64
    v_exp_f32 v65, v65
    v_exp_f32 v66, v66
    v_exp_f32_e64 v67, v67
    v_cvt_pk_bf16_f32 v52, v64, v65
    v_cvt_pk_bf16_f32 v53, v66, v67
    ds_read_b64_tr_b16 v[48:49], v14 offset:4352
    ds_read_b64_tr_b16 v[50:51], v14 offset:4480
    v_exp_f32 v68, v68
    v_exp_f32 v69, v69
    v_exp_f32 v70, v70
    v_exp_f32 v71, v71
    v_cvt_pk_bf16_f32 v54, v68, v69
    v_cvt_pk_bf16_f32 v55, v70, v71
    v_mfma_f32_32x32x8_bf16 v[80:95], v[38:39], v[36:37], v[80:95]
    ds_read_b64 v[38:39], v13 offset:3072
    v_exp_f32 v72, v72
    v_exp_f32 v73, v73
    v_exp_f32 v74, v74
    v_exp_f32 v75, v75
    v_cvt_pk_bf16_f32 v56, v72, v73
    v_cvt_pk_bf16_f32 v57, v74, v75
    s_waitcnt lgkmcnt(4)
    v_mfma_f32_32x32x16_bf16 v[96:111], v[44:47], v[52:55], 0
    ds_read_b64_tr_b16 v[44:45], v14 offset:3584
    ds_read_b64_tr_b16 v[46:47], v14 offset:3712
    v_exp_f32 v76, v76
    v_exp_f32 v77, v77
    v_exp_f32 v78, v78
    v_exp_f32 v79, v79
    v_cvt_pk_bf16_f32 v58, v76, v77
    v_cvt_pk_bf16_f32 v59, v78, v79
    s_bitcmp1_b32 s35, 2
    s_cbranch_scc1 L_hw2
L_hr2:
    s_waitcnt lgkmcnt(2)
    v_mfma_f32_32x32x16_bf16 v[64:79], v[40:43], v[32:35], 0
    ds_read_b128 v[40:43], v12 offset:2560
    v_exp_f32 v80, v80
    v_exp_f32 v81, v81
    v_exp_f32 v82, v82
    v_exp_f32 v83, v83
    v_cvt_pk_bf16_f32 v52, v80, v81
    v_cvt_pk_bf16_f32 v53, v82, v83
    v_mfma_f32_32x32x16_bf16 v[96:111], v[48:51], v[56:59], v[96:111]
    ds_read_b64_tr_b16 v[48:49], v14 offset:3840
    ds_read_b64_tr_b16 v[50:51], v14 offset:3968
    v_exp_f32 v84, v84
    v_exp_f32 v85, v85
    v_exp_f32 v86, v86
    v_exp_f32 v87, v87
    v_cvt_pk_bf16_f32 v54, v84, v85
    v_cvt_pk_bf16_f32 v55, v86, v87
    v_mfma_f32_32x32x8_bf16 v[64:79], v[38:39], v[36:37], v[64:79]
    ds_read_b64 v[38:39], v13 offset:2560
    v_exp_f32 v88, v88
    v_exp_f32 v89, v89
    v_exp_f32 v90, v90
    v_exp_f32 v91, v91
    v_cvt_pk_bf16_f32 v56, v88, v89
    v_cvt_pk_bf16_f32 v57, v90, v91
    s_waitcnt lgkmcnt(4)
    v_mfma_f32_32x32x16_bf16 v[96:111], v[44:47], v[52:55], v[96:111]
    ds_read_b64_tr_b16 v[44:45], v14 offset:3072
    ds_read_b64_tr_b16 v[46:47], v14 offset:3200
    v_exp_f32 v92, v92
    v_exp_f32 v93, v93
    v_exp_f32 v94, v94
    v_exp_f32 v95, v95
    v_cvt_pk_bf16_f32 v58, v92, v93
    v_cvt_pk_bf16_f32 v59, v94, v95
    s_bitcmp1_b32 s35, 3
    s_cbranch_scc1 L_hw3
L_hr3:
    s_waitcnt lgkmcnt(2)
    v_mfma_f32_32x32x16_bf16 v[80:95], v[40:43], v[32:35], 0
    ds_read_b128 v[40:43], v12 offset:2048
    v_exp_f32 v64, v64
    v_exp_f32 v65, v65
    v_exp_f32 v66, v66
    v_exp_f32 v67, v67
    v_cvt_pk_bf16_f32 v52, v64, v65
    v_cvt_pk_bf16_f32 v53, v66, v67
    v_mfma_f32_32x32x16_bf16 v[96:111], v[48:51], v[56:59], v[96:111]
    ds_read_b64_tr_b16 v[48:49], v14 offset:3328
    ds_read_b64_tr_b16 v[50:51], v14 offset:3456
    v_exp_f32 v68, v68
    v_exp_f32 v69, v69
    v_exp_f32 v70, v70
    v_exp_f32 v71, v71
    v_cvt_pk_bf16_f32 v54, v68, v69
    v_cvt_pk_bf16_f32 v55, v70, v71
    v_mfma_f32_32x32x8_bf16 v[80:95], v[38:39], v[36:37], v[80:95]
    ds_read_b64 v[38:39], v13 offset:2048
    v_exp_f32 v72, v72
    v_exp_f32 v73, v73
    v_exp_f32 v74, v74
    v_exp_f32 v75, v75
    v_cvt_pk_bf16_f32 v56, v72, v73
    v_cvt_pk_bf16_f32 v57, v74, v75
    s_waitcnt lgkmcnt(4)
    v_mfma_f32_32x32x16_bf16 v[96:111], v[44:47], v[52:55], v[96:111]
    ds_read_b64_tr_b16 v[44:45], v14 offset:2560
    ds_read_b64_tr_b16 v[46:47], v14 offset:2688
    v_exp_f32 v76, v76
    v_exp_f32 v77, v77
    v_exp_f32 v78, v78
    v_exp_f32 v79, v79
    v_cvt_pk_bf16_f32 v58, v76, v77
    v_cvt_pk_bf16_f32 v59, v78, v79
    s_bitcmp1_b32 s35, 4
    s_cbranch_scc1 L_hw4
L_hr4:
    s_waitcnt lgkmcnt(2)
    v_mfma_f32_32x32x16_bf16 v[64:79], v[40:43], v[32:35], 0
    ds_read_b128 v[40:43], v12 offset:1536
    v_exp_f32 v80, v80
    v_exp_f32 v81, v81
    v_exp_f32 v82, v82
    v_exp_f32 v83, v83
    v_cvt_pk_bf16_f32 v52, v80, v81
    v_cvt_pk_bf16_f32 v53, v82, v83
    v_mfma_f32_32x32x16_bf16 v[96:111], v[48:51], v[56:59], v[96:111]
    ds_read_b64_tr_b16 v[48:49], v14 offset:2816
    ds_read_b64_tr_b16 v[50:51], v14 offset:2944
    v_exp_f32 v84, v84
    v_exp_f32 v85, v85
    v_exp_f32 v86, v86
    v_exp_f32 v87, v87
    v_cvt_pk_bf16_f32 v54, v84, v85
    v_cvt_pk_bf16_f32 v55, v86, v87
    v_mfma_f32_32x32x8_bf16 v[64:79], v[38:39], v[36:37], v[64:79]
    ds_read_b64 v[38:39], v13 offset:1536
    v_exp_f32 v88, v88
    v_exp_f32 v89, v89
    v_exp_f32 v90, v90
    v_exp_f32 v91, v91
    v_cvt_pk_bf16_f32 v56, v88, v89
    v_cvt_pk_bf16_f32 v57, v90, v91
    s_waitcnt lgkmcnt(4)
    v_mfma_f32_32x32x16_bf16 v[96:111], v[44:47], v[52:55], v[96:111]
    ds_read_b64_tr_b16 v[44:45], v14 offset:2048
    ds_read_b64_tr_b16 v[46:47], v14 offset:2176
    v_exp_f32 v92, v92
    v_exp_f32 v93, v93
    v_exp_f32 v94, v94
    v_exp_f32 v95, v95
    v_cvt_pk_bf16_f32 v58, v92, v93
    v_cvt_pk_bf16_f32 v59, v94, v95
    s_bitcmp1_b32 s35, 5
    s_cbranch_scc1 L_hw5
L_hr5:
    s_waitcnt lgkmcnt(2)
    v_mfma_f32_32x32x16_bf16 v[80:95], v[40:43], v[32:35], 0
    ds_read_b128 v[40:43], v12 offset:1024
    v_exp_f32 v64, v64
    v_exp_f32 v65, v65
    v_exp_f32 v66, v66
    v_exp_f32 v67, v67
    v_cvt_pk_bf16_f32 v52, v64, v65
    v_cvt_pk_bf16_f32 v53, v66, v67
    v_mfma_f32_32x32x16_bf16 v[96:111], v[48:51], v[56:59], v[96:111]
    ds_read_b64_tr_b16 v[48:49], v14 offset:2304
    ds_read_b64_tr_b16 v[50:51], v14 offset:2432
    v_exp_f32 v68, v68
    v_exp_f32 v69, v69
    v_exp_f32 v70, v70
    v_exp_f32 v71, v71
    v_cvt_pk_bf16_f32 v54, v68, v69
    v_cvt_pk_bf16_f32 v55, v70, v71
    v_mfma_f32_32x32x8_bf16 v[80:95], v[38:39], v[36:37], v[80:95]
    ds_read_b64 v[38:39], v13 offset:1024
    v_exp_f32 v72, v72
    v_exp_f32 v73, v73
    v_exp_f32 v74, v74
    v_exp_f32 v75, v75
    v_cvt_pk_bf16_f32 v56, v72, v73
    v_cvt_pk_bf16_f32 v57, v74, v75
    s_waitcnt lgkmcnt(4)
    v_mfma_f32_32x32x16_bf16 v[96:111], v[44:47], v[52:55], v[96:111]
    ds_read_b64_tr_b16 v[44:45], v14 offset:1536
    ds_read_b64_tr_b16 v[46:47], v14 offset:1664
    v_exp_f32 v76, v76
    v_exp_f32 v77, v77
    v_exp_f32 v78, v78
    v_exp_f32 v79, v79
    v_cvt_pk_bf16_f32 v58, v76, v77
    v_cvt_pk_bf16_f32 v59, v78, v79
    s_bitcmp1_b32 s35, 6
    s_cbranch_scc1 L_hw6
L_hr6:
    s_waitcnt lgkmcnt(2)
    v_mfma_f32_32x32x16_bf16 v[64:79], v[40:43], v[32:35], 0
    ds_read_b128 v[40:43], v12 offset:512
    v_exp_f32 v80, v80
    v_exp_f32 v81, v81
    v_exp_f32 v82, v82
    v_exp_f32 v83, v83
    v_cvt_pk_bf16_f32 v52, v80, v81
    v_cvt_pk_bf16_f32 v53, v82, v83
    v_mfma_f32_32x32x16_bf16 v[96:111], v[48:51], v[56:59], v[96:111]
    ds_read_b64_tr_b16 v[48:49], v14 offset:1792
    ds_read_b64_tr_b16 v[50:51], v14 offset:1920
    v_exp_f32 v84, v84
    v_exp_f32 v85, v85
    v_exp_f32 v86, v86
    v_exp_f32 v87, v87
    v_cvt_pk_bf16_f32 v54, v84, v85
    v_cvt_pk_bf16_f32 v55, v86, v87
    v_mfma_f32_32x32x8_bf16 v[64:79], v[38:39], v[36:37], v[64:79]
    ds_read_b64 v[38:39], v13 offset:512
    v_exp_f32 v88, v88
    v_exp_f32 v89, v89
    v_exp_f32 v90, v90
    v_exp_f32 v91, v91
    v_cvt_pk_bf16_f32 v56, v88, v89
    v_cvt_pk_bf16_f32 v57, v90, v91
    s_waitcnt lgkmcnt(4)
    v_mfma_f32_32x32x16_bf16 v[96:111], v[44:47], v[52:55], v[96:111]
    ds_read_b64_tr_b16 v[44:45], v14 offset:1024
    ds_read_b64_tr_b16 v[46:47], v14 offset:1152
    v_exp_f32 v92, v92
    v_exp_f32 v93, v93
    v_exp_f32 v94, v94
    v_exp_f32 v95, v95
    v_cvt_pk_bf16_f32 v58, v92, v93
    v_cvt_pk_bf16_f32 v59, v94, v95
    s_bitcmp1_b32 s35, 7
    s_cbranch_scc1 L_hw7
L_hr7:
    s_waitcnt lgkmcnt(2)
    v_mfma_f32_32x32x16_bf16 v[80:95], v[40:43], v[32:35], 0
    ds_read_b128 v[40:43], v12 offset:0
    v_exp_f32 v64, v64
    v_exp_f32 v65, v65
    v_exp_f32 v66, v66
    v_exp_f32 v67, v67
    v_cvt_pk_bf16_f32 v52, v64, v65
    v_cvt_pk_bf16_f32 v53, v66, v67
    v_mfma_f32_32x32x16_bf16 v[96:111], v[48:51], v[56:59], v[96:111]
    ds_read_b64_tr_b16 v[48:49], v14 offset:1280
    ds_read_b64_tr_b16 v[50:51], v14 offset:1408
    v_exp_f32 v68, v68
    v_exp_f32 v69, v69
    v_exp_f32 v70, v70
    v_exp_f32 v71, v71
    v_cvt_pk_bf16_f32 v54, v68, v69
    v_cvt_pk_bf16_f32 v55, v70, v71
    v_mfma_f32_32x32x8_bf16 v[80:95], v[38:39], v[36:37], v[80:95]
    ds_read_b64 v[38:39], v13 offset:0
    v_exp_f32 v72, v72
    v_exp_f32 v73, v73
    v_exp_f32 v74, v74
    v_exp_f32 v75, v75
    v_cvt_pk_bf16_f32 v56, v72, v73
    v_cvt_pk_bf16_f32 v57, v74, v75
    s_waitcnt lgkmcnt(4)
    v_mfma_f32_32x32x16_bf16 v[96:111], v[44:47], v[52:55], v[96:111]
    ds_read_b64_tr_b16 v[44:45], v14 offset:512
    ds_read_b64_tr_b16 v[46:47], v14 offset:640
    v_exp_f32 v76, v76
    v_exp_f32 v77, v77
    v_exp_f32 v78, v78
    v_exp_f32 v79, v79
    v_cvt_pk_bf16_f32 v58, v76, v77
    v_cvt_pk_bf16_f32 v59, v78, v79
    s_bitcmp1_b32 s35, 8
    s_cbranch_scc1 L_hw8
L_hr8:
    s_waitcnt lgkmcnt(2)
    v_mfma_f32_32x32x16_bf16 v[64:79], v[40:43], v[32:35], v[112:127]
    v_exp_f32 v80, v80
    v_exp_f32 v81, v81
    v_exp_f32 v82, v82
    v_exp_f32 v83, v83
    v_cvt_pk_bf16_f32 v52, v80, v81
    v_cvt_pk_bf16_f32 v53, v82, v83
    v_mfma_f32_32x32x16_bf16 v[96:111], v[48:51], v[56:59], v[96:111]
    ds_read_b64_tr_b16 v[48:49], v14 offset:768
    ds_read_b64_tr_b16 v[50:51], v14 offset:896
    v_exp_f32 v84, v84
    v_exp_f32 v85, v85
    v_exp_f32 v86, v86
    v_exp_f32 v87, v87
    v_cvt_pk_bf16_f32 v54, v84, v85
    v_cvt_pk_bf16_f32 v55, v86, v87
    v_mfma_f32_32x32x8_bf16 v[64:79], v[38:39], v[36:37], v[64:79]
    v_exp_f32 v88, v88
    v_exp_f32 v89, v89
    v_exp_f32 v90, v90
    v_exp_f32 v91, v91
    v_cvt_pk_bf16_f32 v56, v88, v89
    v_cvt_pk_bf16_f32 v57, v90, v91
    s_waitcnt lgkmcnt(2)
    v_mfma_f32_32x32x16_bf16 v[96:111], v[44:47], v[52:55], v[96:111]
    s_nop 0
    ds_read_b64_tr_b16 v[44:45], v14 offset:0
    ds_read_b64_tr_b16 v[46:47], v14 offset:128
    v_exp_f32 v92, v92
    v_exp_f32 v93, v93
    v_exp_f32 v94, v94
    v_exp_f32 v95, v95
    v_cvt_pk_bf16_f32 v58, v92, v93
    v_cvt_pk_bf16_f32 v59, v94, v95
    s_bitcmp1_b32 s35, 9
    s_cbranch_scc1 L_hw9
L_hr9:
    s_waitcnt lgkmcnt(2)
    v_exp_f32 v64, v64
    v_exp_f32 v65, v65
    v_exp_f32 v66, v66
    v_exp_f32_e64 v67, v67
    v_cvt_pk_bf16_f32 v52, v64, v65
    v_cvt_pk_bf16_f32 v53, v66, v67
    v_mfma_f32_32x32x16_bf16 v[96:111], v[48:51], v[56:59], v[96:111]
    ds_read_b64_tr_b16 v[48:49], v14 offset:256
    ds_read_b64_tr_b16 v[50:51], v14 offset:384
    v_exp_f32 v68, v68
    v_exp_f32 v69, v69
    v_exp_f32 v70, v70
    v_exp_f32 v71, v71
    v_cvt_pk_bf16_f32 v54, v68, v69
    v_cvt_pk_bf16_f32 v55, v70, v71
    v_exp_f32 v72, v72
    v_exp_f32 v73, v73
    v_exp_f32 v74, v74
    v_exp_f32_e64 v75, v75
    v_cvt_pk_bf16_f32 v56, v72, v73
    v_cvt_pk_bf16_f32 v57, v74, v75
    s_waitcnt lgkmcnt(2)
    v_mfma_f32_32x32x16_bf16 v[96:111], v[44:47], v[52:55], v[96:111]
    v_exp_f32 v76, v76
    v_exp_f32 v77, v77
    v_exp_f32 v78, v78
    v_exp_f32 v79, v79
    v_cvt_pk_bf16_f32 v58, v76, v77
    v_cvt_pk_bf16_f32 v59, v78, v79
L_att_fin:
    s_waitcnt lgkmcnt(0)
    s_nop 0
    v_mfma_f32_32x32x16_bf16 v[96:111], v[48:51], v[56:59], v[96:111]
    s_lshl_b32 s36, s29, 3
    s_add_u32 s36, s36, s33
    s_lshl_b32 s36, s36, 5
    s_add_u32 s36, s36, s30
    s_lshl_b32 s36, s36, 2
    s_add_u32 s36, s36, 17104896
    s_mov_b32 s37, 0x1f800000
    s_mov_b32 s38, 0x5f800000
    s_nop 3
    v_rcp_f32 v8, v108
    v_cmp_nle_f32 s[44:45], s37, v108
    v_cmp_nge_f32 vcc, s38, v108
    v_mul_f32 v8, v8, v17
    s_or_b64 vcc, vcc, s[44:45]
    v_pk_mul_f32 v[6:7], v[96:97], 0
    v_pk_fma_f32 v[6:7], v[98:99], 0, v[6:7]
    v_pk_fma_f32 v[6:7], v[100:101], 0, v[6:7]
    v_pk_fma_f32 v[6:7], v[102:103], 0, v[6:7]
    v_pk_fma_f32 v[6:7], v[104:105], 0, v[6:7]
    v_pk_fma_f32 v[6:7], v[106:107], 0, v[6:7]
    v_cmp_u_f32 s[44:45], v6, v7
    s_or_b64 vcc, vcc, s[44:45]
    s_cbranch_vccnz L_fallback
L_att_ok:
    v_pk_mul_f32 v[96:97], v[96:97], v[8:9] op_sel_hi:[1,0]
    v_pk_mul_f32 v[98:99], v[98:99], v[8:9] op_sel_hi:[1,0]
    v_pk_mul_f32 v[100:101], v[100:101], v[8:9] op_sel_hi:[1,0]
    v_pk_mul_f32 v[102:103], v[102:103], v[8:9] op_sel_hi:[1,0]
    v_pk_mul_f32 v[104:105], v[104:105], v[8:9] op_sel_hi:[1,0]
    v_pk_mul_f32 v[106:107], v[106:107], v[8:9] op_sel_hi:[1,0]
    v_cvt_pk_bf16_f32 v52, v96, v97
    v_cvt_pk_bf16_f32 v53, v98, v99
    v_cvt_pk_bf16_f32 v54, v100, v101
    v_cvt_pk_bf16_f32 v55, v102, v103
    v_cvt_pk_bf16_f32 v56, v104, v105
    v_cvt_pk_bf16_f32 v57, v106, v107
    s_cmp_eq_u32 s61, 0
    s_cbranch_scc1 L_imp5
    buffer_store_dwordx4 v[52:55], v15, s[24:27], s46 offen nt
    buffer_store_dwordx2 v[56:57], v16, s[24:27], s47 offen nt
    s_mov_b64 exec, 1
    ds_add_u32 v30, v2 offset:32
    ds_read_b64 v[62:63], v30 offset:16
    s_waitcnt vmcnt(0)
    buffer_store_dword v163, off, s[24:27], s36
    s_mov_b64 exec, -1
    s_branch L_ime6
L_imp5:
    buffer_store_dwordx4 v[52:55], v15, s[24:27], s46 offen sc1
    buffer_store_dwordx2 v[56:57], v16, s[24:27], s47 offen sc1
    s_mov_b64 exec, 1
    ds_add_u32 v30, v2 offset:32
    ds_read_b64 v[62:63], v30 offset:16
    s_waitcnt vmcnt(0)
    buffer_store_dword v163, off, s[24:27], s36 sc1
    s_mov_b64 exec, -1
L_ime6:
    s_cmp_lt_u32 s28, 4
    s_cbranch_scc1 L_op_main
    s_waitcnt lgkmcnt(0)
    s_endpgm
L_op_main:
    s_setprio 0
    s_mov_b32 s50, 262144
L_lw7:
    ds_read_b32 v9, v30 offset:8
    s_sub_u32 s50, s50, 1
    s_cbranch_scc1 L_lo8
    s_waitcnt lgkmcnt(0)
    v_cmp_gt_u32 vcc, 1, v9
    s_cbranch_vccnz L_lw7
L_lo8:
    s_mov_b32 s50, 262144
L_tv:
    v_readfirstlane_b32 s42, v62
    v_readfirstlane_b32 s43, v63
    s_cmp_lg_u32 s42, 0
    s_cbranch_scc1 L_to
    ds_read_b64 v[62:63], v30 offset:16
    s_sub_u32 s50, s50, 1
    s_waitcnt lgkmcnt(0)
    s_cbranch_scc0 L_tv
L_to:
    s_and_b32 s42, s42, 0xffff
    ds_read_b128 v[32:35], v150 offset:0
    ds_read_b128 v[36:39], v150 offset:1024
    ds_read_b128 v[40:43], v150 offset:2048
    ds_read_b128 v[44:47], v150 offset:3072
    ds_read_b128 v[48:51], v150 offset:4096
    ds_read_b128 v[52:55], v150 offset:5120
    ds_read_b128 v[56:59], v150 offset:6144
    ds_read_b128 v[60:63], v150 offset:7168
    ds_read_b128 v[64:67], v150 offset:8192
    ds_read_b128 v[68:71], v150 offset:9216
    ds_read_b128 v[72:75], v150 offset:10240
    ds_read_b128 v[76:79], v150 offset:11264
    ds_read_b128 v[80:83], v150 offset:12288
    ds_read_b128 v[84:87], v150 offset:13312
    ds_read_b128 v[88:91], v150 offset:14336
    v_cmp_eq_u32 s[44:45], s43, v162
    v_cmp_eq_u32 s[48:49], s42, v162
    s_mov_b32 s50, 262144
L_lw9:
    ds_read_b32 v9, v30 offset:32
    s_sub_u32 s50, s50, 1
    s_cbranch_scc1 L_lo10
    s_waitcnt lgkmcnt(0)
    v_cmp_gt_u32 vcc, 8, v9
    s_cbranch_vccnz L_lw9
L_lo10:
    s_mov_b32 s50, 32768
L_poll11:
    buffer_load_dword v6, v160, s[24:27], s57 offen sc1
    s_sub_u32 s50, s50, 1
    s_cbranch_scc1 L_pout12
    s_waitcnt vmcnt(0)
    v_cmp_ne_u32 vcc, s60, v6
    s_cbranch_vccnz L_poll11
L_pout12:
    s_waitcnt vmcnt(0)
    buffer_load_dwordx4 v[92:95], v148, s[24:27], s58 offen sc1
    s_add_u32 s58, s58, 20480
    buffer_load_dwordx4 v[96:99], v148, s[24:27], s58 offen sc1
    s_add_u32 s58, s58, 20480
    buffer_load_dwordx4 v[100:103], v148, s[24:27], s58 offen sc1
    s_add_u32 s58, s58, 20480
    s_or_b64 s[48:49], s[44:45], s[48:49]
    s_cbranch_scc0 L_op_loop
    v_mov_b32 v7, 320
    v_cndmask_b32_e64 v7, 0, v7, s[44:45]
    v_add_u32 v7, v7, v161
    s_mov_b32 s50, 262144
    s_waitcnt lgkmcnt(0)
L_yw:
    ds_read_b32 v9, v30 offset:36
    ds_read_b128 v[104:107], v7 offset:512
    ds_read_b128 v[108:111], v7 offset:576
    ds_read_b128 v[112:115], v7 offset:640
    ds_read_b128 v[116:119], v7 offset:704
    ds_read_b128 v[120:123], v7 offset:768
    s_sub_u32 s50, s50, 1
    s_waitcnt lgkmcnt(0)
    s_cbranch_scc1 L_op_loop
    v_cmp_ne_u32 vcc, 1, v9
    s_cbranch_vccnz L_yw
    s_mov_b64 exec, s[48:49]
    v_fmac_f32 v128, v18, v104
    v_fmac_f32 v129, v18, v105
    v_fmac_f32 v130, v18, v106
    v_fmac_f32 v131, v18, v107
    v_fmac_f32 v132, v18, v108
    v_fmac_f32 v133, v18, v109
    v_fmac_f32 v134, v18, v110
    v_fmac_f32 v135, v18, v111
    v_fmac_f32 v136, v18, v112
    v_fmac_f32 v137, v18, v113
    v_fmac_f32 v138, v18, v114
    v_fmac_f32 v139, v18, v115
    v_fmac_f32 v140, v18, v116
    v_fmac_f32 v141, v18, v117
    v_fmac_f32 v142, v18, v118
    v_fmac_f32 v143, v18, v119
    v_fmac_f32 v144, v18, v120
    v_fmac_f32 v145, v18, v121
    v_fmac_f32 v146, v18, v122
    v_fmac_f32 v147, v18, v123
    s_mov_b64 exec, -1
L_op_loop:
    s_waitcnt vmcnt(2) lgkmcnt(10)
    v_mfma_f32_16x16x32_bf16 v[128:131], v[32:35], v[92:95], v[128:131]
    ds_read_b128 v[32:35], v150 offset:15360
    s_nop 0
    buffer_load_dwordx4 v[104:107], v148, s[24:27], s58 offen sc1
    s_add_u32 s58, s58, 20480
    v_mfma_f32_16x16x32_bf16 v[132:135], v[36:39], v[92:95], v[132:135]
    ds_read_b128 v[36:39], v150 offset:16384
    v_mfma_f32_16x16x32_bf16 v[136:139], v[40:43], v[92:95], v[136:139]
    ds_read_b128 v[40:43], v150 offset:17408
    buffer_load_dwordx4 v[108:111], v148, s[24:27], s58 offen sc1
    s_add_u32 s58, s58, 20480
    v_mfma_f32_16x16x32_bf16 v[140:143], v[44:47], v[92:95], v[140:143]
    ds_read_b128 v[44:47], v150 offset:18432
    v_mfma_f32_16x16x32_bf16 v[144:147], v[48:51], v[92:95], v[144:147]
    ds_read_b128 v[48:51], v150 offset:19456
    s_waitcnt vmcnt(3) lgkmcnt(10)
    v_mfma_f32_16x16x32_bf16 v[128:131], v[52:55], v[96:99], v[128:131]
    ds_read_b128 v[52:55], v150 offset:20480
    buffer_load_dwordx4 v[112:115], v148, s[24:27], s58 offen sc1
    s_nop 0
    s_add_u32 s58, s58, 20480
    v_mfma_f32_16x16x32_bf16 v[132:135], v[56:59], v[96:99], v[132:135]
    ds_read_b128 v[56:59], v150 offset:21504
    v_mfma_f32_16x16x32_bf16 v[136:139], v[60:63], v[96:99], v[136:139]
    ds_read_b128 v[60:63], v150 offset:22528
    buffer_load_dwordx4 v[116:119], v148, s[24:27], s58 offen sc1
    s_add_u32 s58, s58, 20480
    v_mfma_f32_16x16x32_bf16 v[140:143], v[64:67], v[96:99], v[140:143]
    ds_read_b128 v[64:67], v150 offset:23552
    v_mfma_f32_16x16x32_bf16 v[144:147], v[68:71], v[96:99], v[144:147]
    ds_read_b128 v[68:71], v150 offset:24576
    s_waitcnt vmcnt(4) lgkmcnt(10)
    s_nop 0
    v_mfma_f32_16x16x32_bf16 v[128:131], v[72:75], v[100:103], v[128:131]
    ds_read_b128 v[72:75], v150 offset:25600
    buffer_load_dwordx4 v[120:123], v148, s[24:27], s58 offen sc1
    s_add_u32 s58, s58, 20480
    v_mfma_f32_16x16x32_bf16 v[132:135], v[76:79], v[100:103], v[132:135]
    ds_read_b128 v[76:79], v150 offset:26624
    v_mfma_f32_16x16x32_bf16 v[136:139], v[80:83], v[100:103], v[136:139]
    ds_read_b128 v[80:83], v150 offset:27648
    v_mfma_f32_16x16x32_bf16 v[140:143], v[84:87], v[100:103], v[140:143]
    ds_read_b128 v[84:87], v150 offset:28672
    v_mfma_f32_16x16x32_bf16 v[144:147], v[88:91], v[100:103], v[144:147]
    ds_read_b128 v[88:91], v150 offset:29696
    s_waitcnt vmcnt(4) lgkmcnt(10)
    v_mfma_f32_16x16x32_bf16 v[128:131], v[32:35], v[104:107], v[128:131]
    ds_read_b128 v[32:35], v150 offset:30720
    buffer_load_dwordx4 v[124:127], v148, s[24:27], s58 offen sc1
    s_nop 0
    s_add_u32 s58, s58, 20480
    v_mfma_f32_16x16x32_bf16 v[132:135], v[36:39], v[104:107], v[132:135]
    ds_read_b128 v[36:39], v150 offset:31744
    v_mfma_f32_16x16x32_bf16 v[136:139], v[40:43], v[104:107], v[136:139]
    ds_read_b128 v[40:43], v150 offset:32768
    v_mfma_f32_16x16x32_bf16 v[140:143], v[44:47], v[104:107], v[140:143]
    ds_read_b128 v[44:47], v150 offset:33792
    v_mfma_f32_16x16x32_bf16 v[144:147], v[48:51], v[104:107], v[144:147]
    ds_read_b128 v[48:51], v150 offset:34816
    s_waitcnt vmcnt(4) lgkmcnt(10)
    v_mfma_f32_16x16x32_bf16 v[128:131], v[52:55], v[108:111], v[128:131]
    ds_read_b128 v[52:55], v150 offset:35840
    s_nop 0
    buffer_load_dwordx4 v[92:95], v148, s[24:27], s58 offen sc1
    s_add_u32 s58, s58, 20480
    v_mfma_f32_16x16x32_bf16 v[132:135], v[56:59], v[108:111], v[132:135]
    ds_read_b128 v[56:59], v150 offset:36864
    v_mfma_f32_16x16x32_bf16 v[136:139], v[60:63], v[108:111], v[136:139]
    ds_read_b128 v[60:63], v150 offset:37888
    v_mfma_f32_16x16x32_bf16 v[140:143], v[64:67], v[108:111], v[140:143]
    ds_read_b128 v[64:67], v150 offset:38912
    v_mfma_f32_16x16x32_bf16 v[144:147], v[68:71], v[108:111], v[144:147]
    ds_read_b128 v[68:71], v150 offset:39936
    s_waitcnt vmcnt(4) lgkmcnt(10)
    v_mfma_f32_16x16x32_bf16 v[128:131], v[72:75], v[112:115], v[128:131]
    s_nop 0
    ds_read_b128 v[72:75], v150 offset:40960
    buffer_load_dwordx4 v[96:99], v148, s[24:27], s58 offen sc1
    s_add_u32 s58, s58, 20480
    v_mfma_f32_16x16x32_bf16 v[132:135], v[76:79], v[112:115], v[132:135]
    ds_read_b128 v[76:79], v150 offset:41984
    v_mfma_f32_16x16x32_bf16 v[136:139], v[80:83], v[112:115], v[136:139]
    ds_read_b128 v[80:83], v150 offset:43008
    v_mfma_f32_16x16x32_bf16 v[140:143], v[84:87], v[112:115], v[140:143]
    ds_read_b128 v[84:87], v150 offset:44032
    v_mfma_f32_16x16x32_bf16 v[144:147], v[88:91], v[112:115], v[144:147]
    ds_read_b128 v[88:91], v150 offset:45056
    s_waitcnt vmcnt(4) lgkmcnt(10)
    s_nop 0
    v_mfma_f32_16x16x32_bf16 v[128:131], v[32:35], v[116:119], v[128:131]
    ds_read_b128 v[32:35], v150 offset:46080
    buffer_load_dwordx4 v[100:103], v148, s[24:27], s58 offen sc1
    s_add_u32 s58, s58, 20480
    v_mfma_f32_16x16x32_bf16 v[132:135], v[36:39], v[116:119], v[132:135]
    ds_read_b128 v[36:39], v150 offset:47104
    v_mfma_f32_16x16x32_bf16 v[136:139], v[40:43], v[116:119], v[136:139]
    ds_read_b128 v[40:43], v150 offset:48128
    v_mfma_f32_16x16x32_bf16 v[140:143], v[44:47], v[116:119], v[140:143]
    ds_read_b128 v[44:47], v150 offset:49152
    v_mfma_f32_16x16x32_bf16 v[144:147], v[48:51], v[116:119], v[144:147]
    ds_read_b128 v[48:51], v150 offset:50176
    s_waitcnt vmcnt(4) lgkmcnt(10)
    v_mfma_f32_16x16x32_bf16 v[128:131], v[52:55], v[120:123], v[128:131]
    ds_read_b128 v[52:55], v151 offset:0
    buffer_load_dwordx4 v[104:107], v148, s[24:27], s58 offen sc1
    s_nop 0
    s_add_u32 s58, s58, 20480
    v_mfma_f32_16x16x32_bf16 v[132:135], v[56:59], v[120:123], v[132:135]
    ds_read_b128 v[56:59], v151 offset:1024
    v_mfma_f32_16x16x32_bf16 v[136:139], v[60:63], v[120:123], v[136:139]
    ds_read_b128 v[60:63], v151 offset:2048
    v_mfma_f32_16x16x32_bf16 v[140:143], v[64:67], v[120:123], v[140:143]
    ds_read_b128 v[64:67], v151 offset:3072
    v_mfma_f32_16x16x32_bf16 v[144:147], v[68:71], v[120:123], v[144:147]
    ds_read_b128 v[68:71], v151 offset:4096
    s_waitcnt vmcnt(4) lgkmcnt(10)
    v_mfma_f32_16x16x32_bf16 v[128:131], v[72:75], v[124:127], v[128:131]
    ds_read_b128 v[72:75], v151 offset:5120
    s_nop 0
    buffer_load_dwordx4 v[108:111], v148, s[24:27], s58 offen sc1
    s_add_u32 s58, s58, 20480
    v_mfma_f32_16x16x32_bf16 v[132:135], v[76:79], v[124:127], v[132:135]
    ds_read_b128 v[76:79], v151 offset:6144
    v_mfma_f32_16x16x32_bf16 v[136:139], v[80:83], v[124:127], v[136:139]
    ds_read_b128 v[80:83], v151 offset:7168
    v_mfma_f32_16x16x32_bf16 v[140:143], v[84:87], v[124:127], v[140:143]
    ds_read_b128 v[84:87], v151 offset:8192
    v_mfma_f32_16x16x32_bf16 v[144:147], v[88:91], v[124:127], v[144:147]
    ds_read_b128 v[88:91], v151 offset:9216
    s_waitcnt vmcnt(4) lgkmcnt(10)
    v_mfma_f32_16x16x32_bf16 v[128:131], v[32:35], v[92:95], v[128:131]
    s_nop 0
    ds_read_b128 v[32:35], v151 offset:10240
    buffer_load_dwordx4 v[112:115], v148, s[24:27], s58 offen sc1
    s_add_u32 s58, s58, 20480
    v_mfma_f32_16x16x32_bf16 v[132:135], v[36:39], v[92:95], v[132:135]
    ds_read_b128 v[36:39], v151 offset:11264
    v_mfma_f32_16x16x32_bf16 v[136:139], v[40:43], v[92:95], v[136:139]
    ds_read_b128 v[40:43], v151 offset:12288
    v_mfma_f32_16x16x32_bf16 v[140:143], v[44:47], v[92:95], v[140:143]
    ds_read_b128 v[44:47], v151 offset:13312
    v_mfma_f32_16x16x32_bf16 v[144:147], v[48:51], v[92:95], v[144:147]
    ds_read_b128 v[48:51], v151 offset:14336
    s_waitcnt vmcnt(4) lgkmcnt(10)
    s_nop 0
    v_mfma_f32_16x16x32_bf16 v[128:131], v[52:55], v[96:99], v[128:131]
    ds_read_b128 v[52:55], v151 offset:15360
    buffer_load_dwordx4 v[116:119], v148, s[24:27], s58 offen sc1
    s_add_u32 s58, s58, 20480
    v_mfma_f32_16x16x32_bf16 v[132:135], v[56:59], v[96:99], v[132:135]
    ds_read_b128 v[56:59], v151 offset:16384
    v_mfma_f32_16x16x32_bf16 v[136:139], v[60:63], v[96:99], v[136:139]
    ds_read_b128 v[60:63], v151 offset:17408
    v_mfma_f32_16x16x32_bf16 v[140:143], v[64:67], v[96:99], v[140:143]
    ds_read_b128 v[64:67], v151 offset:18432
    v_mfma_f32_16x16x32_bf16 v[144:147], v[68:71], v[96:99], v[144:147]
    ds_read_b128 v[68:71], v151 offset:19456
    s_waitcnt vmcnt(4) lgkmcnt(10)
    v_mfma_f32_16x16x32_bf16 v[128:131], v[72:75], v[100:103], v[128:131]
    ds_read_b128 v[72:75], v151 offset:20480
    buffer_load_dwordx4 v[120:123], v149, s[24:27], s59 offen sc1
    s_nop 0
    s_add_u32 s59, s59, 81920
    v_mfma_f32_16x16x32_bf16 v[132:135], v[76:79], v[100:103], v[132:135]
    ds_read_b128 v[76:79], v151 offset:21504
    v_mfma_f32_16x16x32_bf16 v[136:139], v[80:83], v[100:103], v[136:139]
    ds_read_b128 v[80:83], v151 offset:22528
    v_mfma_f32_16x16x32_bf16 v[140:143], v[84:87], v[100:103], v[140:143]
    ds_read_b128 v[84:87], v151 offset:23552
    v_mfma_f32_16x16x32_bf16 v[144:147], v[88:91], v[100:103], v[144:147]
    ds_read_b128 v[88:91], v151 offset:24576
    s_waitcnt vmcnt(4) lgkmcnt(10)
    v_mfma_f32_16x16x32_bf16 v[128:131], v[32:35], v[104:107], v[128:131]
    ds_read_b128 v[32:35], v151 offset:25600
    s_nop 0
    buffer_load_dwordx4 v[124:127], v149, s[24:27], s59 offen sc1
    s_add_u32 s59, s59, 81920
    v_mfma_f32_16x16x32_bf16 v[132:135], v[36:39], v[104:107], v[132:135]
    ds_read_b128 v[36:39], v151 offset:26624
    v_mfma_f32_16x16x32_bf16 v[136:139], v[40:43], v[104:107], v[136:139]
    ds_read_b128 v[40:43], v151 offset:27648
    v_mfma_f32_16x16x32_bf16 v[140:143], v[44:47], v[104:107], v[140:143]
    ds_read_b128 v[44:47], v151 offset:28672
    v_mfma_f32_16x16x32_bf16 v[144:147], v[48:51], v[104:107], v[144:147]
    ds_read_b128 v[48:51], v151 offset:29696
    s_waitcnt vmcnt(4) lgkmcnt(10)
    v_mfma_f32_16x16x32_bf16 v[128:131], v[52:55], v[108:111], v[128:131]
    s_nop 0
    ds_read_b128 v[52:55], v151 offset:30720
    buffer_load_dwordx4 v[92:95], v149, s[24:27], s59 offen sc1
    s_add_u32 s59, s59, 81920
    v_mfma_f32_16x16x32_bf16 v[132:135], v[56:59], v[108:111], v[132:135]
    ds_read_b128 v[56:59], v151 offset:31744
    v_mfma_f32_16x16x32_bf16 v[136:139], v[60:63], v[108:111], v[136:139]
    ds_read_b128 v[60:63], v151 offset:32768
    v_mfma_f32_16x16x32_bf16 v[140:143], v[64:67], v[108:111], v[140:143]
    ds_read_b128 v[64:67], v151 offset:33792
    v_mfma_f32_16x16x32_bf16 v[144:147], v[68:71], v[108:111], v[144:147]
    ds_read_b128 v[68:71], v151 offset:34816
    s_waitcnt vmcnt(4) lgkmcnt(10)
    s_nop 0
    v_mfma_f32_16x16x32_bf16 v[128:131], v[72:75], v[112:115], v[128:131]
    ds_read_b128 v[72:75], v151 offset:35840
    buffer_load_dwordx4 v[96:99], v149, s[24:27], s59 offen sc1
    s_add_u32 s59, s59, 81920
    v_mfma_f32_16x16x32_bf16 v[132:135], v[76:79], v[112:115], v[132:135]
    ds_read_b128 v[76:79], v151 offset:36864
    v_mfma_f32_16x16x32_bf16 v[136:139], v[80:83], v[112:115], v[136:139]
    ds_read_b128 v[80:83], v151 offset:37888
    v_mfma_f32_16x16x32_bf16 v[140:143], v[84:87], v[112:115], v[140:143]
    ds_read_b128 v[84:87], v151 offset:38912
    v_mfma_f32_16x16x32_bf16 v[144:147], v[88:91], v[112:115], v[144:147]
    ds_read_b128 v[88:91], v151 offset:39936
    s_waitcnt vmcnt(4) lgkmcnt(10)
    v_mfma_f32_16x16x32_bf16 v[128:131], v[32:35], v[116:119], v[128:131]
    ds_read_b128 v[32:35], v151 offset:40960
    v_mfma_f32_16x16x32_bf16 v[132:135], v[36:39], v[116:119], v[132:135]
    s_nop 0
    ds_read_b128 v[36:39], v151 offset:41984
    v_mfma_f32_16x16x32_bf16 v[136:139], v[40:43], v[116:119], v[136:139]
    ds_read_b128 v[40:43], v151 offset:43008
    v_mfma_f32_16x16x32_bf16 v[140:143], v[44:47], v[116:119], v[140:143]
    ds_read_b128 v[44:47], v151 offset:44032
    v_mfma_f32_16x16x32_bf16 v[144:147], v[48:51], v[116:119], v[144:147]
    ds_read_b128 v[48:51], v151 offset:45056
    s_waitcnt vmcnt(3) lgkmcnt(10)
    s_nop 0
    v_mfma_f32_16x16x32_bf16 v[128:131], v[52:55], v[120:123], v[128:131]
    ds_read_b128 v[52:55], v151 offset:46080
    v_mfma_f32_16x16x32_bf16 v[132:135], v[56:59], v[120:123], v[132:135]
    ds_read_b128 v[56:59], v151 offset:47104
    v_mfma_f32_16x16x32_bf16 v[136:139], v[60:63], v[120:123], v[136:139]
    ds_read_b128 v[60:63], v151 offset:48128
    v_mfma_f32_16x16x32_bf16 v[140:143], v[64:67], v[120:123], v[140:143]
    ds_read_b128 v[64:67], v151 offset:49152
    v_mfma_f32_16x16x32_bf16 v[144:147], v[68:71], v[120:123], v[144:147]
    ds_read_b128 v[68:71], v151 offset:50176
    s_waitcnt vmcnt(2) lgkmcnt(10)
    v_mfma_f32_16x16x32_bf16 v[128:131], v[72:75], v[124:127], v[128:131]
    s_nop 0
    v_mfma_f32_16x16x32_bf16 v[132:135], v[76:79], v[124:127], v[132:135]
    v_mfma_f32_16x16x32_bf16 v[136:139], v[80:83], v[124:127], v[136:139]
    v_mfma_f32_16x16x32_bf16 v[140:143], v[84:87], v[124:127], v[140:143]
    v_mfma_f32_16x16x32_bf16 v[144:147], v[88:91], v[124:127], v[144:147]
    s_waitcnt vmcnt(1) lgkmcnt(5)
    v_mfma_f32_16x16x32_bf16 v[128:131], v[32:35], v[92:95], v[128:131]
    v_mfma_f32_16x16x32_bf16 v[132:135], v[36:39], v[92:95], v[132:135]
    v_mfma_f32_16x16x32_bf16 v[136:139], v[40:43], v[92:95], v[136:139]
    s_nop 0
    v_mfma_f32_16x16x32_bf16 v[140:143], v[44:47], v[92:95], v[140:143]
    v_mfma_f32_16x16x32_bf16 v[144:147], v[48:51], v[92:95], v[144:147]
    s_waitcnt vmcnt(0) lgkmcnt(0)
    v_mfma_f32_16x16x32_bf16 v[128:131], v[52:55], v[96:99], v[128:131]
    s_nop 0
    v_mfma_f32_16x16x32_bf16 v[132:135], v[56:59], v[96:99], v[132:135]
    v_mfma_f32_16x16x32_bf16 v[136:139], v[60:63], v[96:99], v[136:139]
    v_mfma_f32_16x16x32_bf16 v[140:143], v[64:67], v[96:99], v[140:143]
    v_mfma_f32_16x16x32_bf16 v[144:147], v[68:71], v[96:99], v[144:147]
L_op_end:
    s_nop 3
    v_cvt_pk_bf16_f32 v32, v128, v129
    v_cvt_pk_bf16_f32 v33, v130, v131
    ds_write_b64 v19, v[32:33] offset:0
    v_cvt_pk_bf16_f32 v34, v132, v133
    v_cvt_pk_bf16_f32 v35, v134, v135
    ds_write_b64 v19, v[34:35] offset:32
    v_cvt_pk_bf16_f32 v36, v136, v137
    v_cvt_pk_bf16_f32 v37, v138, v139
    ds_write_b64 v19, v[36:37] offset:64
    v_cvt_pk_bf16_f32 v38, v140, v141
    v_cvt_pk_bf16_f32 v39, v142, v143
    ds_write_b64 v19, v[38:39] offset:96
    v_cvt_pk_bf16_f32 v40, v144, v145
    v_cvt_pk_bf16_f32 v41, v146, v147
    ds_write_b64 v19, v[40:41] offset:128
    ds_read_b128 v[108:111], v159 offset:0
    ds_read_b128 v[112:115], v159 offset:1024
    ds_read_b128 v[116:119], v159 offset:2048
    s_waitcnt lgkmcnt(2)
    buffer_store_dwordx4 v[108:111], v156, s[52:55], s56 offen nt
    s_waitcnt lgkmcnt(1)
    buffer_store_dwordx4 v[112:115], v157, s[52:55], s56 offen nt
    s_waitcnt lgkmcnt(0)
    buffer_store_dwordx4 v[116:119], v158, s[52:55], s56 offen nt
    s_endpgm
L_help:
    s_cmp_eq_u32 s28, 9
    s_cbranch_scc1 L_ffn
    s_load_dwordx2 s[8:9], s[0:1], 32
    s_load_dwordx2 s[10:11], s[0:1], 64
    v_lshlrev_b32 v10, 4, v1
    v_mov_b32 v16, 0x3f80
    v_mov_b32 v17, 0
    v_mov_b32 v18, 0x3f803f80
    v_mov_b32 v19, 0x3f80
    v_add_u32 v5, 152256, v10
    ds_write_b128 v5, v[16:19] offset:0
    ds_write_b128 v5, v[16:19] offset:1024
    ds_write_b128 v5, v[16:19] offset:2048
    ds_write_b128 v5, v[16:19] offset:3072
    ds_write_b128 v5, v[16:19] offset:4096
    v_mov_b32 v30, 157440
    v_mov_b32 v6, 0
    v_lshl_add_u32 v7, v1, 2, v30
    ds_write_b32 v7, v6
    s_setprio 3
    v_add_u32 v5, 0, v1
    v_mul_u32_u24 v6, 6554, v5
    v_lshrrev_b32 v6, 16, v6
    v_mul_u32_u24 v8, 10, v6
    v_sub_u32 v8, v5, v8
    v_mul_u32_u24 v6, 1280, v6
    v_lshl_add_u32 v160, v8, 4, v6
    v_add_u32 v5, 64, v1
    v_mul_u32_u24 v6, 6554, v5
    v_lshrrev_b32 v6, 16, v6
    v_mul_u32_u24 v8, 10, v6
    v_sub_u32 v8, v5, v8
    v_mul_u32_u24 v6, 1280, v6
    v_lshl_add_u32 v161, v8, 4, v6
    v_add_u32 v5, 128, v1
    v_mul_u32_u24 v6, 6554, v5
    v_lshrrev_b32 v6, 16, v6
    v_mul_u32_u24 v8, 10, v6
    v_sub_u32 v8, v5, v8
    v_mul_u32_u24 v6, 1280, v6
    v_lshl_add_u32 v162, v8, 4, v6
    v_add_u32 v5, 192, v1
    v_mul_u32_u24 v6, 6554, v5
    v_lshrrev_b32 v6, 16, v6
    v_mul_u32_u24 v8, 10, v6
    v_sub_u32 v8, v5, v8
    v_mul_u32_u24 v6, 1280, v6
    v_lshl_add_u32 v163, v8, 4, v6
    v_add_u32 v5, 256, v1
    v_mul_u32_u24 v6, 6554, v5
    v_lshrrev_b32 v6, 16, v6
    v_mul_u32_u24 v8, 10, v6
    v_sub_u32 v8, v5, v8
    v_mul_u32_u24 v6, 1280, v6
    v_lshl_add_u32 v164, v8, 4, v6
    s_waitcnt lgkmcnt(0)
    s_add_u32 s14, s12, 17956864
    s_addc_u32 s15, s13, 0
    s_load_dword s60, s[14:15], 0
    s_mov_b32 s16, s4
    s_mov_b32 s17, s5
    s_mov_b32 s18, 2621440
    s_mov_b32 s19, 0x20000
    s_mov_b32 s24, s12
    s_mov_b32 s25, s13
    s_mov_b32 s26, 19922944
    s_mov_b32 s27, 0x20000
    s_mov_b32 s52, s8
    s_mov_b32 s53, s9
    s_mov_b32 s54, 1280
    s_mov_b32 s55, 0x20000
    s_mov_b32 s56, s10
    s_mov_b32 s57, s11
    s_mov_b32 s58, 1280
    s_mov_b32 s59, 0x20000
    s_cmp_lg_u32 s32, 15
    s_cbranch_scc1 L_nowv
    s_mov_b32 m0, 124416
    s_nop 0
    buffer_load_dwordx4 v10, s[52:55], 0 offen lds
    buffer_load_dwordx4 v10, s[52:55], 0 offen offset:1024 lds
    s_mov_b32 m0, 126464
    s_nop 0
    buffer_load_dwordx4 v10, s[56:59], 0 offen lds
    buffer_load_dwordx4 v10, s[56:59], 0 offen offset:1024 lds
L_nowv:
    s_getreg_b32 s35, hwreg(HW_REG_XCC_ID, 0, 4)
    s_lshr_b32 s34, s30, 2
    s_mul_i32 s34, s34, 160
    s_mul_i32 s33, s30, 5
    s_lshr_b32 s33, s33, 1
    v_bfe_u32 v5, v1, 2, 1
    v_lshl_add_u32 v6, v5, 1, s33
    v_lshrrev_b32 v6, 3, v6
    v_bfe_u32 v7, v1, 3, 2
    v_cmp_eq_u32 s[44:45], 3, v7
    v_and_b32 v8, 3, v1
    v_lshlrev_b32 v8, 2, v8
    v_cndmask_b32_e64 v5, v6, v5, s[44:45]
    v_mad_u32_u24 v5, v7, 10, v5
    v_lshl_add_u32 v11, v5, 4, v8
    v_and_b32 v7, 1, v7
    v_mad_u32_u24 v5, v7, 10, v6
    v_add_u32 v5, 10, v5
    v_lshl_add_u32 v15, v5, 7, v8
    v_and_b32 v14, 31, v1
    v_lshlrev_b32 v14, 3, v14
    s_lshl_b32 s42, s29, 8
    s_add_u32 s42, s42, 16908288
    s_waitcnt lgkmcnt(0)
    s_add_u32 s60, s60, 0x9e3779b9
    s_waitcnt vmcnt(0)
    s_barrier
    s_lshl_b32 s36, s30, 3
    s_add_u32 s36, s36, s42
    v_mov_b32 v8, s60
    v_mov_b32 v9, s35
    v_mov_b32 v5, 0
    s_mov_b64 exec, 1
    buffer_store_dwordx2 v[8:9], v5, s[24:27], s36 offen
    s_mov_b64 exec, -1
    s_and_b32 s38, s30, 3
    s_lshl_b32 s38, s38, 5
    s_lshl_b32 s39, s29, 8
    s_add_u32 s38, s38, s39
    s_mul_i32 s38, s38, 1280
    s_add_u32 s38, s38, s34
    s_add_u32 s39, s38, 163840
    s_cmp_lg_u32 s32, 15
    s_cbranch_scc1 L_h_g
    s_lshl_b32 s36, s29, 10
    s_add_u32 s36, s36, 17104896
    s_lshl_b32 s37, s29, 9
    s_add_u32 s37, s37, 16973824
    v_and_b32 v5, 7, v1
    v_lshlrev_b32 v5, 7, v5
    v_lshrrev_b32 v6, 1, v5
    s_mov_b64 exec, 0xff
    buffer_load_dword v167, v5, s[24:27], s36 offen sc1
    buffer_load_dword v167, v6, s[24:27], s37 offen sc1
    s_mov_b64 exec, -1
    buffer_load_dword v167, v14, s[24:27], s42 offen sc1
    s_barrier
    s_barrier
    s_barrier
    s_barrier
    s_barrier
    s_barrier
    s_barrier
    s_barrier
    s_barrier
    s_mov_b32 s50, 262144
L_lw13:
    ds_read_b32 v9, v30 offset:40
    s_sub_u32 s50, s50, 1
    s_cbranch_scc1 L_lo14
    s_waitcnt lgkmcnt(0)
    v_cmp_gt_u32 vcc, 4, v9
    s_cbranch_vccnz L_lw13
L_lo14:
    s_mov_b32 m0, 140800
    s_nop 0
    buffer_load_dwordx4 v160, s[16:19], s38 offen lds
    s_mov_b32 m0, 141824
    s_nop 0
    buffer_load_dwordx4 v161, s[16:19], s38 offen lds
    s_mov_b32 m0, 142848
    s_nop 0
    buffer_load_dwordx4 v162, s[16:19], s38 offen lds
    s_mov_b32 m0, 143872
    s_nop 0
    buffer_load_dwordx4 v163, s[16:19], s38 offen lds
    s_mov_b32 m0, 144896
    s_nop 0
    buffer_load_dwordx4 v164, s[16:19], s38 offen lds
    s_mov_b32 m0, 145920
    s_nop 0
    buffer_load_dwordx4 v160, s[16:19], s39 offen lds
    s_mov_b32 m0, 146944
    s_nop 0
    buffer_load_dwordx4 v161, s[16:19], s39 offen lds
    s_mov_b32 m0, 147968
    s_nop 0
    buffer_load_dwordx4 v162, s[16:19], s39 offen lds
    s_mov_b32 m0, 148992
    s_nop 0
    buffer_load_dwordx4 v163, s[16:19], s39 offen lds
    s_mov_b32 m0, 150016
    s_nop 0
    buffer_load_dwordx4 v164, s[16:19], s39 offen lds
    buffer_load_dwordx2 v[12:13], v14, s[24:27], s42 offen sc1
    s_waitcnt vmcnt(0)
    v_mov_b32 v9, 1
    s_mov_b64 exec, 1
    ds_add_u32 v30, v9 offset:12
    s_mov_b64 exec, -1
    s_branch L_h_p
L_h_g:
    s_mov_b32 m0, 140800
    s_nop 0
    buffer_load_dwordx4 v160, s[16:19], s38 offen lds
    s_mov_b32 m0, 141824
    s_nop 0
    buffer_load_dwordx4 v161, s[16:19], s38 offen lds
    s_mov_b32 m0, 142848
    s_nop 0
    buffer_load_dwordx4 v162, s[16:19], s38 offen lds
    s_mov_b32 m0, 143872
    s_nop 0
    buffer_load_dwordx4 v163, s[16:19], s38 offen lds
    s_mov_b32 m0, 144896
    s_nop 0
    buffer_load_dwordx4 v164, s[16:19], s38 offen lds
    s_mov_b32 m0, 145920
    s_nop 0
    buffer_load_dwordx4 v160, s[16:19], s39 offen lds
    s_mov_b32 m0, 146944
    s_nop 0
    buffer_load_dwordx4 v161, s[16:19], s39 offen lds
    s_mov_b32 m0, 147968
    s_nop 0
    buffer_load_dwordx4 v162, s[16:19], s39 offen lds
    s_mov_b32 m0, 148992
    s_nop 0
    buffer_load_dwordx4 v163, s[16:19], s39 offen lds
    s_mov_b32 m0, 150016
    s_nop 0
    buffer_load_dwordx4 v164, s[16:19], s39 offen lds
    s_barrier
    s_barrier
    s_mul_i32 s36, s29, 983040
    s_mul_i32 s37, s30, 11008
    s_min_u32 s37, s37, 316672
    s_add_u32 s36, s36, s37
    s_add_u32 s36, s36, 0
    v_min_u32 v5, 42, v1
    v_lshlrev_b32 v5, 7, v5
    buffer_load_dword v167, v5, s[24:27], s36 offen sc1
    s_mul_i32 s36, s29, 983040
    s_mul_i32 s37, s30, 11008
    s_min_u32 s37, s37, 316672
    s_add_u32 s36, s36, s37
    s_add_u32 s36, s36, 5504
    v_min_u32 v5, 42, v1
    v_lshlrev_b32 v5, 7, v5
    buffer_load_dword v167, v5, s[24:27], s36 offen sc1
    s_mul_i32 s36, s29, 30
    s_add_u32 s36, s36, s30
    s_lshl_b32 s36, s36, 10
    s_add_u32 s36, s36, 17170432
    s_mov_b64 exec, 0xff
    buffer_load_dword v167, v5, s[24:27], s36 offen sc1
    s_mov_b64 exec, -1
    s_barrier
    s_barrier
    s_barrier
    s_barrier
    buffer_load_dwordx2 v[12:13], v14, s[24:27], s42 offen sc1
    s_barrier
    s_barrier
L_h_p:
    s_waitcnt vmcnt(0)
    v_cmp_ne_u32 vcc, s60, v12
    v_cmp_ne_u32 s[44:45], s35, v13
    s_or_b64 vcc, vcc, s[44:45]
    s_cselect_b32 s36, 0, 1
    v_mov_b32 v5, s36
    ds_write_b32 v30, v5
    s_waitcnt lgkmcnt(0)
    s_cmp_eq_u32 s32, 15
    s_cbranch_scc1 L_h_q
    s_barrier
L_h_q:
    s_mov_b32 s50, 262144
L_lw15:
    ds_read_b32 v9, v30 offset:40
    s_sub_u32 s50, s50, 1
    s_cbranch_scc1 L_lo16
    s_waitcnt lgkmcnt(0)
    v_cmp_gt_u32 vcc, 4, v9
    s_cbranch_vccnz L_lw15
L_lo16:
    s_lshl_b32 s36, s29, 9
    s_add_u32 s36, s36, 16973824
    s_mov_b32 s50, 32768
L_poll17:
    buffer_load_dword v12, v11, s[24:27], s36 offen sc1
    s_sub_u32 s50, s50, 1
    s_cbranch_scc1 L_pout18
    s_waitcnt vmcnt(0)
    v_cmp_ne_u32 vcc, s60, v12
    s_cbranch_vccnz L_poll17
L_pout18:
    s_waitcnt vmcnt(0)
    s_lshl_b32 s36, s29, 12
    s_add_u32 s36, s36, 17002496
    s_barrier
    buffer_load_dword v12, v15, s[24:27], s36 offen sc1
    s_lshr_b32 s43, s30, 2
    s_mul_i32 s43, s43, 102400
    s_add_u32 s43, s43, 18022400
    s_mov_b32 s45, 17072128
    v_lshrrev_b32 v5, 2, v1
    v_and_b32 v6, 3, v1
    v_lshlrev_b32 v6, 2, v6
    v_lshl_add_u32 v16, v5, 7, v6
    v_mov_b32 v17, 1
    v_mov_b32 v18, 2
    s_cmp_eq_u32 s29, 0
    s_cbranch_scc1 L_nofr
    s_mov_b32 s50, 32768
    s_branch L_poll19p
L_poll19:
    buffer_load_dword v12, v15, s[24:27], s36 offen sc1
L_poll19p:
    s_sub_u32 s50, s50, 1
    s_cbranch_scc1 L_pout20
    s_waitcnt vmcnt(0)
    v_cmp_ne_u32 vcc, s60, v12
    s_cbranch_vccnz L_poll19
L_pout20:
    s_waitcnt vmcnt(0)
L_nofr:
    s_mov_b32 s50, 262144
L_lw21:
    ds_read_b32 v9, v30 offset:44
    s_sub_u32 s50, s50, 1
    s_cbranch_scc1 L_lo22
    s_waitcnt lgkmcnt(0)
    v_cmp_gt_u32 vcc, 5, v9
    s_cbranch_vccnz L_lw21
L_lo22:
    s_cmp_eq_u32 s29, 0
    s_cbranch_scc1 L_wlate
    s_mul_i32 s36, s29, 240
    s_add_u32 s36, s36, s33
    s_lshl_b32 s36, s36, 12
    s_add_u32 s36, s36, 4294311936
    s_mov_b32 m0, 3072
    s_add_u32 s37, s36, 3072
    buffer_load_dwordx4 v10, s[24:27], s37 offen sc1 lds
    s_mov_b32 m0, 11328
    s_add_u32 s37, s36, 7168
    buffer_load_dwordx4 v10, s[24:27], s37 offen sc1 lds
    s_mov_b32 m0, 19584
    s_add_u32 s37, s36, 11264
    buffer_load_dwordx4 v10, s[24:27], s37 offen sc1 lds
    s_mov_b32 m0, 27904
    s_add_u32 s37, s36, 330752
    buffer_load_dwordx4 v10, s[24:27], s37 offen sc1 lds
    s_mov_b32 m0, 36160
    s_add_u32 s37, s36, 334848
    buffer_load_dwordx4 v10, s[24:27], s37 offen sc1 lds
    s_mov_b32 m0, 44416
    s_add_u32 s37, s36, 338944
    buffer_load_dwordx4 v10, s[24:27], s37 offen sc1 lds
    s_mov_b32 m0, 2048
    s_add_u32 s37, s36, 2048
    buffer_load_dwordx4 v10, s[24:27], s37 offen sc1 lds
    s_mov_b32 m0, 10304
    s_add_u32 s37, s36, 6144
    buffer_load_dwordx4 v10, s[24:27], s37 offen sc1 lds
    s_mov_b32 m0, 18560
    s_add_u32 s37, s36, 10240
    buffer_load_dwordx4 v10, s[24:27], s37 offen sc1 lds
    s_mov_b32 m0, 26880
    s_add_u32 s37, s36, 329728
    buffer_load_dwordx4 v10, s[24:27], s37 offen sc1 lds
    s_mov_b32 m0, 35136
    s_add_u32 s37, s36, 333824
    buffer_load_dwordx4 v10, s[24:27], s37 offen sc1 lds
    s_mov_b32 m0, 43392
    s_add_u32 s37, s36, 337920
    buffer_load_dwordx4 v10, s[24:27], s37 offen sc1 lds
    buffer_load_dword v12, v16, s[24:27], s45 offen sc1
    s_mov_b32 m0, 1024
    s_add_u32 s37, s36, 1024
    buffer_load_dwordx4 v10, s[24:27], s37 offen sc1 lds
    s_mov_b32 m0, 9280
    s_add_u32 s37, s36, 5120
    buffer_load_dwordx4 v10, s[24:27], s37 offen sc1 lds
    s_mov_b32 m0, 17536
    s_add_u32 s37, s36, 9216
    buffer_load_dwordx4 v10, s[24:27], s37 offen sc1 lds
    s_mov_b32 m0, 25856
    s_add_u32 s37, s36, 328704
    buffer_load_dwordx4 v10, s[24:27], s37 offen sc1 lds
    s_mov_b32 m0, 34112
    s_add_u32 s37, s36, 332800
    buffer_load_dwordx4 v10, s[24:27], s37 offen sc1 lds
    s_mov_b32 m0, 42368
    s_add_u32 s37, s36, 336896
    buffer_load_dwordx4 v10, s[24:27], s37 offen sc1 lds
    s_mov_b32 m0, 0
    s_add_u32 s37, s36, 0
    buffer_load_dwordx4 v10, s[24:27], s37 offen sc1 lds
    s_mov_b32 m0, 8256
    s_add_u32 s37, s36, 4096
    buffer_load_dwordx4 v10, s[24:27], s37 offen sc1 lds
    s_mov_b32 m0, 16512
    s_add_u32 s37, s36, 8192
    buffer_load_dwordx4 v10, s[24:27], s37 offen sc1 lds
    s_mov_b32 m0, 24832
    s_add_u32 s37, s36, 327680
    buffer_load_dwordx4 v10, s[24:27], s37 offen sc1 lds
    s_mov_b32 m0, 33088
    s_add_u32 s37, s36, 331776
    buffer_load_dwordx4 v10, s[24:27], s37 offen sc1 lds
    s_mov_b32 m0, 41344
    s_add_u32 s37, s36, 335872
    buffer_load_dwordx4 v10, s[24:27], s37 offen sc1 lds
    s_waitcnt vmcnt(13)
    ds_write_b32 v30, v17 offset:4
    s_waitcnt vmcnt(12)
    v_cmp_ne_u32 vcc, s60, v12
    s_cbranch_vccz L_wok
L_wlate:
    s_waitcnt vmcnt(0)
    ds_write_b32 v30, v18 offset:4
    s_mov_b32 s50, 32768
L_poll23:
    buffer_load_dword v12, v16, s[24:27], s45 offen sc1
    s_sub_u32 s50, s50, 1
    s_cbranch_scc1 L_pout24
    s_waitcnt vmcnt(0)
    v_cmp_ne_u32 vcc, s60, v12
    s_cbranch_vccnz L_poll23
L_pout24:
    s_waitcnt vmcnt(0)
L_wok:
    s_mov_b32 m0, 49664
    s_add_u32 s41, s43, 0
    s_movk_i32 s44, 0x1000
L_wo25:
    buffer_load_dwordx4 v10, s[24:27], s41 offen offset:0 sc1 lds
    buffer_load_dwordx4 v10, s[24:27], s41 offen offset:1024 sc1 lds
    buffer_load_dwordx4 v10, s[24:27], s41 offen offset:2048 sc1 lds
    buffer_load_dwordx4 v10, s[24:27], s41 offen offset:3072 sc1 lds
    s_add_u32 m0, m0, s44
    s_add_u32 s41, s41, s44
    s_cmp_lt_u32 m0, 61952
    s_cbranch_scc1 L_wo25
    s_waitcnt vmcnt(12)
    ds_write_b32 v30, v18 offset:4
    s_mov_b32 m0, 61952
    s_add_u32 s41, s43, 12288
    s_movk_i32 s44, 0x1000
L_wo26:
    buffer_load_dwordx4 v10, s[24:27], s41 offen offset:0 sc1 lds
    buffer_load_dwordx4 v10, s[24:27], s41 offen offset:1024 sc1 lds
    buffer_load_dwordx4 v10, s[24:27], s41 offen offset:2048 sc1 lds
    buffer_load_dwordx4 v10, s[24:27], s41 offen offset:3072 sc1 lds
    s_add_u32 m0, m0, s44
    s_add_u32 s41, s41, s44
    s_cmp_lt_u32 m0, 131584
    s_cbranch_scc1 L_wo26
    s_mov_b32 s50, 262144
L_lw27:
    ds_read_b32 v9, v30 offset:52
    s_sub_u32 s50, s50, 1
    s_cbranch_scc1 L_lo28
    s_waitcnt lgkmcnt(0)
    v_cmp_gt_u32 vcc, 1, v9
    s_cbranch_vccnz L_lw27
L_lo28:
    s_mov_b32 m0, 131584
    s_add_u32 s41, s43, 81920
    s_movk_i32 s44, 0x1000
L_wo29:
    buffer_load_dwordx4 v10, s[24:27], s41 offen offset:0 sc1 lds
    buffer_load_dwordx4 v10, s[24:27], s41 offen offset:1024 sc1 lds
    buffer_load_dwordx4 v10, s[24:27], s41 offen offset:2048 sc1 lds
    buffer_load_dwordx4 v10, s[24:27], s41 offen offset:3072 sc1 lds
    s_add_u32 m0, m0, s44
    s_add_u32 s41, s41, s44
    s_cmp_lt_u32 m0, 152064
    s_cbranch_scc1 L_wo29
    s_waitcnt vmcnt(0)
    v_mov_b32 v9, 1
    s_mov_b64 exec, 1
    ds_add_u32 v30, v9 offset:8
    s_mov_b64 exec, -1
    s_waitcnt lgkmcnt(0)
    s_cmp_lg_u32 s2, 255
    s_cbranch_scc1 L_h1_end
    s_mov_b32 s36, 17694720
    v_min_u32 v5, 59, v1
    v_lshlrev_b32 v5, 10, v5
    s_mov_b32 s50, 262144
L_lw30:
    ds_read_b32 v9, v30 offset:16
    s_sub_u32 s50, s50, 1
    s_cbranch_scc1 L_lo31
    s_waitcnt lgkmcnt(0)
    v_cmp_gt_u32 vcc, 1, v9
    s_cbranch_vccnz L_lw30
L_lo31:
    s_and_b32 s52, s60, 0xff
    s_bfe_u32 s53, s60, 0x80008
    s_bfe_u32 s54, s60, 0x80010
    s_lshr_b32 s55, s60, 24
    s_mov_b32 s50, 32768
L_ep:
    buffer_load_dwordx4 v[32:35], v5, s[24:27], s36 offen offset:0 sc1
    buffer_load_dwordx4 v[36:39], v5, s[24:27], s36 offen offset:256 sc1
    buffer_load_dwordx4 v[40:43], v5, s[24:27], s36 offen offset:512 sc1
    buffer_load_dwordx4 v[44:47], v5, s[24:27], s36 offen offset:768 sc1
    v_mov_b32 v9, 0
    s_waitcnt vmcnt(3)
    v_xor_b32 v32, s52, v32
    v_xor_b32 v33, s53, v33
    v_xor_b32 v34, s54, v34
    v_xor_b32 v35, s55, v35
    v_or3_b32 v9, v9, v32, v33
    v_or3_b32 v9, v9, v34, v35
    s_waitcnt vmcnt(2)
    v_xor_b32 v36, s52, v36
    v_xor_b32 v37, s53, v37
    v_xor_b32 v38, s54, v38
    v_xor_b32 v39, s55, v39
    v_or3_b32 v9, v9, v36, v37
    v_or3_b32 v9, v9, v38, v39
    s_waitcnt vmcnt(1)
    v_xor_b32 v40, s52, v40
    v_xor_b32 v41, s53, v41
    v_xor_b32 v42, s54, v42
    v_xor_b32 v43, s55, v43
    v_or3_b32 v9, v9, v40, v41
    v_or3_b32 v9, v9, v42, v43
    s_waitcnt vmcnt(0)
    v_xor_b32 v44, s52, v44
    v_xor_b32 v45, s53, v45
    v_xor_b32 v46, s54, v46
    v_xor_b32 v47, s55, v47
    v_or3_b32 v9, v9, v44, v45
    v_or3_b32 v9, v9, v46, v47
    v_and_b32 v9, 0xff, v9
    v_cmp_ne_u32 vcc, 0, v9
    s_sub_u32 s50, s50, 1
    s_cbranch_scc1 L_epo
    s_cbranch_vccnz L_ep
L_epo:
    s_mov_b32 s36, 17956864
    v_mov_b32 v8, s60
    v_mov_b32 v9, 0
    s_mov_b64 exec, 1
    buffer_store_dword v8, v9, s[24:27], s36 offen sc1
    s_mov_b64 exec, -1
L_h1_end:
    s_endpgm
L_ffn:
    s_load_dwordx4 s[8:11], s[0:1], 40
    s_load_dwordx2 s[40:41], s[0:1], 56
    s_load_dwordx2 s[44:45], s[0:1], 16
    s_load_dwordx2 s[46:47], s[0:1], 72
    v_lshlrev_b32 v10, 4, v1
    s_mul_i32 s33, s29, 30
    s_add_u32 s33, s33, s30
    s_mul_i32 s34, s33, 6554
    s_lshr_b32 s34, s34, 16
    s_mul_i32 s35, s34, 10
    s_sub_u32 s35, s33, s35
    v_lshrrev_b32 v5, 3, v1
    v_and_b32 v7, 7, v1
    v_mul_u32_u24 v6, 3072, v5
    v_lshl_add_u32 v11, v7, 4, v6
    v_mul_u32_u24 v6, 1280, v5
    v_lshl_add_u32 v12, v7, 4, v6
    v_bfe_u32 v6, v1, 2, 2
    v_lshl_add_u32 v6, v4, 3, v6
    v_lshlrev_b32 v6, 7, v6
    v_and_b32 v8, 3, v1
    v_lshl_add_u32 v6, v8, 3, v6
    v_add_u32 v13, 116224, v6
    v_mov_b32 v30, 157440
    s_mul_i32 s38, s35, 64*3072
    s_lshl_b32 s36, s34, 7
    s_add_u32 s38, s38, s36
    s_mul_i32 s39, s34, 64*1280
    s_lshl_b32 s36, s35, 7
    s_add_u32 s39, s39, s36
    s_waitcnt lgkmcnt(0)
    s_add_u32 s14, s12, 17956864
    s_addc_u32 s15, s13, 0
    s_load_dword s60, s[14:15], 0
    s_mov_b32 s16, s4
    s_mov_b32 s17, s5
    s_mov_b32 s18, 2621440
    s_mov_b32 s19, 0x20000
    s_mov_b32 s20, s40
    s_mov_b32 s21, s41
    s_mov_b32 s22, 1966080
    s_mov_b32 s23, 0x20000
    s_mov_b32 s24, s12
    s_mov_b32 s25, s13
    s_mov_b32 s26, 19922944
    s_mov_b32 s27, 0x20000
    s_mov_b32 s52, s8
    s_mov_b32 s53, s9
    s_mov_b32 s54, 1966080
    s_mov_b32 s55, 0x20000
    s_mov_b32 s56, s10
    s_mov_b32 s57, s11
    s_mov_b32 s58, 1966080
    s_mov_b32 s59, 0x20000
    s_waitcnt lgkmcnt(0)
    s_add_u32 s60, s60, 0x9e3779b9
    s_setprio 3
    s_mov_b32 s51, 16842752
    s_cmp_lg_u32 s32, 15
    s_cbranch_scc1 L_f_w
    s_mul_i32 s36, s29, 983040
    s_sub_u32 s37, s36, 983040
    s_max_i32 s37, s37, 0
    s_load_dword s3, s[44:45], 0
    s_load_dword s3, s[12:13], s36
    s_load_dword s3, s[8:9], 0
    s_load_dword s3, s[10:11], 0
    s_load_dword s3, s[40:41], 0
    s_load_dword s3, s[12:13], s37
    s_add_u32 s36, s36, 982976
    s_mul_i32 s37, s29, 327680
    s_load_dword s3, s[12:13], s36
    s_load_dword s3, s[6:7], 0
    s_mov_b32 s36, 2457536
    s_load_dword s3, s[6:7], s36
    s_barrier
    s_barrier
    s_barrier
    s_barrier
    s_barrier
    s_barrier
    s_barrier
    s_barrier
    s_barrier
    s_barrier
    s_waitcnt lgkmcnt(0)
    s_mov_b32 s3, 1
    s_mov_b32 s50, 32768
    s_branch L_f_b1
L_f_w:
    s_barrier
    s_barrier
    s_barrier
    s_barrier
    s_barrier
    s_barrier
    s_barrier
    s_barrier
    s_barrier
    s_waitcnt lgkmcnt(0)
    buffer_load_dwordx4 v[24:27], v10, s[24:27], s51 offen sc1
    s_mov_b32 m0, 116224
    s_add_u32 s36, s38, 0
    buffer_load_dwordx4 v11, s[52:55], s36 offen nt lds
    s_mov_b32 m0, 117248
    s_add_u32 s36, s38, 24576
    buffer_load_dwordx4 v11, s[52:55], s36 offen nt lds
    s_mov_b32 m0, 118272
    s_add_u32 s36, s38, 49152
    buffer_load_dwordx4 v11, s[52:55], s36 offen nt lds
    s_mov_b32 m0, 119296
    s_add_u32 s36, s38, 73728
    buffer_load_dwordx4 v11, s[52:55], s36 offen nt lds
    s_mov_b32 m0, 120320
    s_add_u32 s36, s38, 98304
    buffer_load_dwordx4 v11, s[52:55], s36 offen nt lds
    s_mov_b32 m0, 121344
    s_add_u32 s36, s38, 122880
    buffer_load_dwordx4 v11, s[52:55], s36 offen nt lds
    s_mov_b32 m0, 122368
    s_add_u32 s36, s38, 147456
    buffer_load_dwordx4 v11, s[52:55], s36 offen nt lds
    s_mov_b32 m0, 123392
    s_add_u32 s36, s38, 172032
    buffer_load_dwordx4 v11, s[52:55], s36 offen nt lds
    s_mov_b32 m0, 124416
    s_add_u32 s36, s38, 0
    buffer_load_dwordx4 v11, s[56:59], s36 offen nt lds
    s_mov_b32 m0, 125440
    s_add_u32 s36, s38, 24576
    buffer_load_dwordx4 v11, s[56:59], s36 offen nt lds
    s_mov_b32 m0, 126464
    s_add_u32 s36, s38, 49152
    buffer_load_dwordx4 v11, s[56:59], s36 offen nt lds
    s_mov_b32 m0, 127488
    s_add_u32 s36, s38, 73728
    buffer_load_dwordx4 v11, s[56:59], s36 offen nt lds
    s_mov_b32 m0, 128512
    s_add_u32 s36, s38, 98304
    buffer_load_dwordx4 v11, s[56:59], s36 offen nt lds
    s_mov_b32 m0, 129536
    s_add_u32 s36, s38, 122880
    buffer_load_dwordx4 v11, s[56:59], s36 offen nt lds
    s_mov_b32 m0, 130560
    s_add_u32 s36, s38, 147456
    buffer_load_dwordx4 v11, s[56:59], s36 offen nt lds
    s_mov_b32 m0, 131584
    s_add_u32 s36, s38, 172032
    buffer_load_dwordx4 v11, s[56:59], s36 offen nt lds
    s_mov_b32 s3, 0
    s_mov_b32 s50, 32768
    s_barrier
    s_waitcnt vmcnt(16)
L_f_chk:
    v_xor_b32 v9, s60, v25
    v_bitop3_b32 v9, v9, v27, s60 bitop3:0xf6
    v_cmp_ne_u32 vcc, 0, v9
    s_cbranch_vccz L_f_ok
    s_sub_u32 s50, s50, 1
    s_cbranch_scc1 L_f_ok
    s_cmp_eq_u32 s3, 2
    s_cbranch_scc1 L_f_again
    s_cmp_eq_u32 s3, 1
    s_cbranch_scc1 L_f_b1
    s_cmp_eq_u32 s50, 32767
    s_cbranch_scc1 L_f_again
    s_waitcnt vmcnt(0)
    s_mov_b32 m0, 132608
    s_add_u32 s36, s39, 0
    buffer_load_dwordx4 v12, s[20:23], s36 offen nt lds
    s_mov_b32 m0, 133632
    s_add_u32 s36, s39, 10240
    buffer_load_dwordx4 v12, s[20:23], s36 offen nt lds
    s_mov_b32 m0, 134656
    s_add_u32 s36, s39, 20480
    buffer_load_dwordx4 v12, s[20:23], s36 offen nt lds
    s_mov_b32 m0, 135680
    s_add_u32 s36, s39, 30720
    buffer_load_dwordx4 v12, s[20:23], s36 offen nt lds
    s_mov_b32 m0, 136704
    s_add_u32 s36, s39, 40960
    buffer_load_dwordx4 v12, s[20:23], s36 offen nt lds
    s_mov_b32 m0, 137728
    s_add_u32 s36, s39, 51200
    buffer_load_dwordx4 v12, s[20:23], s36 offen nt lds
    s_mov_b32 m0, 138752
    s_add_u32 s36, s39, 61440
    buffer_load_dwordx4 v12, s[20:23], s36 offen nt lds
    s_mov_b32 m0, 139776
    s_add_u32 s36, s39, 71680
    buffer_load_dwordx4 v12, s[20:23], s36 offen nt lds
    ds_read_b64_tr_b16 v[64:65], v13 offset:0
    ds_read_b64_tr_b16 v[66:67], v13 offset:512
    ds_read_b64_tr_b16 v[68:69], v13 offset:4096
    ds_read_b64_tr_b16 v[70:71], v13 offset:4608
    ds_read_b64_tr_b16 v[72:73], v13 offset:32
    ds_read_b64_tr_b16 v[74:75], v13 offset:544
    ds_read_b64_tr_b16 v[76:77], v13 offset:4128
    ds_read_b64_tr_b16 v[78:79], v13 offset:4640
    s_waitcnt lgkmcnt(4)
    ds_read_b64_tr_b16 v[80:81], v13 offset:64
    ds_read_b64_tr_b16 v[82:83], v13 offset:576
    ds_read_b64_tr_b16 v[84:85], v13 offset:4160
    ds_read_b64_tr_b16 v[86:87], v13 offset:4672
    ds_read_b64_tr_b16 v[88:89], v13 offset:96
    ds_read_b64_tr_b16 v[90:91], v13 offset:608
    ds_read_b64_tr_b16 v[92:93], v13 offset:4192
    ds_read_b64_tr_b16 v[94:95], v13 offset:4704
    s_waitcnt lgkmcnt(4)
    ds_read_b64_tr_b16 v[96:97], v13 offset:8192
    ds_read_b64_tr_b16 v[98:99], v13 offset:8704
    ds_read_b64_tr_b16 v[100:101], v13 offset:12288
    ds_read_b64_tr_b16 v[102:103], v13 offset:12800
    ds_read_b64_tr_b16 v[104:105], v13 offset:8224
    ds_read_b64_tr_b16 v[106:107], v13 offset:8736
    ds_read_b64_tr_b16 v[108:109], v13 offset:12320
    ds_read_b64_tr_b16 v[110:111], v13 offset:12832
    s_waitcnt lgkmcnt(4)
    ds_read_b64_tr_b16 v[112:113], v13 offset:8256
    ds_read_b64_tr_b16 v[114:115], v13 offset:8768
    ds_read_b64_tr_b16 v[116:117], v13 offset:12352
    ds_read_b64_tr_b16 v[118:119], v13 offset:12864
    ds_read_b64_tr_b16 v[120:121], v13 offset:8288
    ds_read_b64_tr_b16 v[122:123], v13 offset:8800
    ds_read_b64_tr_b16 v[124:125], v13 offset:12384
    ds_read_b64_tr_b16 v[126:127], v13 offset:12896
    s_waitcnt lgkmcnt(4)
    s_waitcnt lgkmcnt(0)
    s_mov_b32 s3, 1
    s_branch L_f_again
L_f_b1:
    s_barrier
    s_mov_b32 s3, 2
L_f_again:
    buffer_load_dwordx4 v[24:27], v10, s[24:27], s51 offen sc1
    s_waitcnt vmcnt(0)
    s_branch L_f_chk
L_f_ok:
    s_and_b32 s52, s60, 0xff
    s_bfe_u32 s53, s60, 0x80008
    s_bfe_u32 s54, s60, 0x80010
    s_lshr_b32 s55, s60, 24
    v_max_u32 v21, v24, v26
    s_nop 1
    v_max_u32_dpp v21, v21, v21 row_shr:1 row_mask:0xf bank_mask:0xf bound_ctrl:1
    s_nop 1
    v_max_u32_dpp v21, v21, v21 row_shr:2 row_mask:0xf bank_mask:0xf bound_ctrl:1
    s_nop 1
    v_max_u32_dpp v21, v21, v21 row_shr:4 row_mask:0xf bank_mask:0xf bound_ctrl:1
    s_nop 1
    v_max_u32_dpp v21, v21, v21 row_shr:8 row_mask:0xf bank_mask:0xf bound_ctrl:1
    s_nop 1
    v_max_u32_dpp v21, v21, v21 row_bcast:15 row_mask:0xa bank_mask:0xf
    s_nop 1
    v_max_u32_dpp v21, v21, v21 row_bcast:31 row_mask:0xc bank_mask:0xf
    s_nop 0
    v_readlane_b32 s40, v21, 63
    s_nop 1
    v_cmp_ne_u32 s[44:45], s40, v24
    s_nop 1
    v_cndmask_b32_e64 v24, 0, v24, s[44:45]
    v_cmp_ne_u32 s[44:45], s40, v26
    s_nop 1
    v_cndmask_b32_e64 v26, 0, v26, s[44:45]
    v_max_u32 v21, v24, v26
    s_nop 1
    v_max_u32_dpp v21, v21, v21 row_shr:1 row_mask:0xf bank_mask:0xf bound_ctrl:1
    s_nop 1
    v_max_u32_dpp v21, v21, v21 row_shr:2 row_mask:0xf bank_mask:0xf bound_ctrl:1
    s_nop 1
    v_max_u32_dpp v21, v21, v21 row_shr:4 row_mask:0xf bank_mask:0xf bound_ctrl:1
    s_nop 1
    v_max_u32_dpp v21, v21, v21 row_shr:8 row_mask:0xf bank_mask:0xf bound_ctrl:1
    s_nop 1
    v_max_u32_dpp v21, v21, v21 row_bcast:15 row_mask:0xa bank_mask:0xf
    s_nop 1
    v_max_u32_dpp v21, v21, v21 row_bcast:31 row_mask:0xc bank_mask:0xf
    s_nop 0
    v_readlane_b32 s41, v21, 63
    s_and_b32 s42, s40, 0xffff
    s_sub_u32 s42, 0xffff, s42
    s_and_b32 s42, s42, 0x7ff
    s_ashr_i32 s36, s40, 31
    s_not_b32 s36, s36
    s_or_b32 s36, s36, 0x80000000
    s_xor_b32 s46, s40, s36
    s_and_b32 s46, s46, 0xffff0000
    s_and_b32 s43, s41, 0xffff
    s_sub_u32 s43, 0xffff, s43
    s_and_b32 s43, s43, 0x7ff
    s_ashr_i32 s36, s41, 31
    s_not_b32 s36, s36
    s_or_b32 s36, s36, 0x80000000
    s_xor_b32 s47, s41, s36
    s_and_b32 s47, s47, 0xffff0000
    v_mov_b32 v16, s42
    v_mov_b32 v17, s43
    v_mov_b32 v18, s46
    v_mov_b32 v19, s47
    v_or_b32 v16, 0x10000, v16
    ds_write_b128 v30, v[16:19] offset:16
    v_mov_b32 v20, s42
    v_and_b32 v6, 1, v1
    v_cmp_eq_u32 s[44:45], 0, v6
    s_lshl_b32 s36, s35, 7
    s_nop 0
    v_cndmask_b32_e64 v7, v17, v20, s[44:45]
    v_mul_u32_u24 v7, 1280, v7
    v_lshl_add_u32 v7, v4, 4, v7
    s_cmp_lg_u32 s32, 15
    s_cbranch_scc1 L_f_job
    v_mov_b32 v9, 1
    s_mov_b64 exec, 1
    ds_add_u32 v30, v9 offset:52
    s_mov_b64 exec, -1
    s_branch L_f_gather
L_f_job:
    buffer_load_dwordx4 v[24:27], v7, s[16:19], s36 offen
    buffer_load_dwordx4 v[160:163], v7, s[16:19], s36 offen offset:64
    v_cmp_eq_u32 s[44:45], 1, v4
    v_cmp_eq_u32 s[46:47], 2, v4
    v_cmp_eq_u32 s[48:49], 3, v4
    v_and_b32 v22, 3, v1
    v_lshlrev_b32 v22, 3, v22
    v_bfe_u32 v22, s60, v22, 8
    v_lshlrev_b32 v23, 2, v1
    v_mov_b32 v21, 0xffffff00
    ds_read_b32 v31, v30
    s_waitcnt lgkmcnt(0)
    v_readfirstlane_b32 s61, v31
    s_cmp_lg_u32 s3, 0
    s_cbranch_scc1 L_f_nf
    s_waitcnt vmcnt(2)
    s_mov_b32 m0, 132608
    s_add_u32 s36, s39, 0
    buffer_load_dwordx4 v12, s[20:23], s36 offen nt lds
    s_mov_b32 m0, 133632
    s_add_u32 s36, s39, 10240
    buffer_load_dwordx4 v12, s[20:23], s36 offen nt lds
    s_mov_b32 m0, 134656
    s_add_u32 s36, s39, 20480
    buffer_load_dwordx4 v12, s[20:23], s36 offen nt lds
    s_mov_b32 m0, 135680
    s_add_u32 s36, s39, 30720
    buffer_load_dwordx4 v12, s[20:23], s36 offen nt lds
    s_mov_b32 m0, 136704
    s_add_u32 s36, s39, 40960
    buffer_load_dwordx4 v12, s[20:23], s36 offen nt lds
    s_mov_b32 m0, 137728
    s_add_u32 s36, s39, 51200
    buffer_load_dwordx4 v12, s[20:23], s36 offen nt lds
    s_mov_b32 m0, 138752
    s_add_u32 s36, s39, 61440
    buffer_load_dwordx4 v12, s[20:23], s36 offen nt lds
    s_mov_b32 m0, 139776
    s_add_u32 s36, s39, 71680
    buffer_load_dwordx4 v12, s[20:23], s36 offen nt lds
    ds_read_b64_tr_b16 v[64:65], v13 offset:0
    ds_read_b64_tr_b16 v[66:67], v13 offset:512
    ds_read_b64_tr_b16 v[68:69], v13 offset:4096
    ds_read_b64_tr_b16 v[70:71], v13 offset:4608
    ds_read_b64_tr_b16 v[72:73], v13 offset:32
    ds_read_b64_tr_b16 v[74:75], v13 offset:544
    ds_read_b64_tr_b16 v[76:77], v13 offset:4128
    ds_read_b64_tr_b16 v[78:79], v13 offset:4640
    s_waitcnt lgkmcnt(4)
    ds_read_b64_tr_b16 v[80:81], v13 offset:64
    ds_read_b64_tr_b16 v[82:83], v13 offset:576
    ds_read_b64_tr_b16 v[84:85], v13 offset:4160
    ds_read_b64_tr_b16 v[86:87], v13 offset:4672
    ds_read_b64_tr_b16 v[88:89], v13 offset:96
    ds_read_b64_tr_b16 v[90:91], v13 offset:608
    ds_read_b64_tr_b16 v[92:93], v13 offset:4192
    ds_read_b64_tr_b16 v[94:95], v13 offset:4704
    s_waitcnt lgkmcnt(4)
    ds_read_b64_tr_b16 v[96:97], v13 offset:8192
    ds_read_b64_tr_b16 v[98:99], v13 offset:8704
    ds_read_b64_tr_b16 v[100:101], v13 offset:12288
    ds_read_b64_tr_b16 v[102:103], v13 offset:12800
    ds_read_b64_tr_b16 v[104:105], v13 offset:8224
    ds_read_b64_tr_b16 v[106:107], v13 offset:8736
    ds_read_b64_tr_b16 v[108:109], v13 offset:12320
    ds_read_b64_tr_b16 v[110:111], v13 offset:12832
    s_waitcnt lgkmcnt(4)
    ds_read_b64_tr_b16 v[112:113], v13 offset:8256
    ds_read_b64_tr_b16 v[114:115], v13 offset:8768
    ds_read_b64_tr_b16 v[116:117], v13 offset:12352
    ds_read_b64_tr_b16 v[118:119], v13 offset:12864
    ds_read_b64_tr_b16 v[120:121], v13 offset:8288
    ds_read_b64_tr_b16 v[122:123], v13 offset:8800
    ds_read_b64_tr_b16 v[124:125], v13 offset:12384
    ds_read_b64_tr_b16 v[126:127], v13 offset:12896
    s_waitcnt lgkmcnt(4)
    s_waitcnt lgkmcnt(0)
    s_waitcnt vmcnt(8)
    s_branch L_f_s1
L_f_nf:
    s_cmp_lg_u32 s3, 1
    s_cbranch_scc1 L_f_nb
    s_barrier
L_f_nb:
    s_waitcnt vmcnt(0)
L_f_s1:
    v_mfma_f32_16x16x32_bf16 v[32:35], v[24:27], v[64:67], 0
    v_mfma_f32_16x16x32_bf16 v[36:39], v[24:27], v[72:75], 0
    v_mfma_f32_16x16x32_bf16 v[40:43], v[24:27], v[80:83], 0
    v_mfma_f32_16x16x32_bf16 v[44:47], v[24:27], v[88:91], 0
    v_mfma_f32_16x16x32_bf16 v[48:51], v[24:27], v[96:99], 0
    v_mfma_f32_16x16x32_bf16 v[52:55], v[24:27], v[104:107], 0
    v_mfma_f32_16x16x32_bf16 v[56:59], v[24:27], v[112:115], 0
    v_mfma_f32_16x16x32_bf16 v[60:63], v[24:27], v[120:123], 0
    v_mfma_f32_16x16x32_bf16 v[32:35], v[160:163], v[68:71], v[32:35]
    v_mfma_f32_16x16x32_bf16 v[36:39], v[160:163], v[76:79], v[36:39]
    v_mfma_f32_16x16x32_bf16 v[40:43], v[160:163], v[84:87], v[40:43]
    v_mfma_f32_16x16x32_bf16 v[44:47], v[160:163], v[92:95], v[44:47]
    v_mfma_f32_16x16x32_bf16 v[48:51], v[160:163], v[100:103], v[48:51]
    v_mfma_f32_16x16x32_bf16 v[52:55], v[160:163], v[108:111], v[52:55]
    v_mfma_f32_16x16x32_bf16 v[56:59], v[160:163], v[116:119], v[56:59]
    v_mfma_f32_16x16x32_bf16 v[60:63], v[160:163], v[124:127], v[60:63]
    s_lshl_b32 s36, s33, 10
    s_add_u32 s36, s36, 17170432
    s_nop 2
    v_cndmask_b32_e64 v96, v32, v36, s[44:45]
    v_cndmask_b32_e64 v96, v96, v40, s[46:47]
    v_cndmask_b32_e64 v96, v96, v44, s[48:49]
    v_cndmask_b32_e64 v97, v33, v37, s[44:45]
    v_cndmask_b32_e64 v97, v97, v41, s[46:47]
    v_cndmask_b32_e64 v97, v97, v45, s[48:49]
    v_cndmask_b32_e64 v98, v48, v52, s[44:45]
    v_cndmask_b32_e64 v98, v98, v56, s[46:47]
    v_cndmask_b32_e64 v98, v98, v60, s[48:49]
    v_cndmask_b32_e64 v99, v49, v53, s[44:45]
    v_cndmask_b32_e64 v99, v99, v57, s[46:47]
    v_cndmask_b32_e64 v99, v99, v61, s[48:49]
    v_and_or_b32 v96, v96, v21, s52
    v_and_or_b32 v97, v97, v21, s53
    v_and_or_b32 v98, v98, v21, s54
    v_and_or_b32 v99, v99, v21, s55
    s_cmp_eq_u32 s61, 0
    s_cbranch_scc1 L_imp32
    buffer_store_dwordx4 v[96:99], v10, s[24:27], s36 offen
    s_branch L_ime33
L_imp32:
    buffer_store_dwordx4 v[96:99], v10, s[24:27], s36 offen sc1
L_ime33:
    s_mul_i32 s36, s34, 10240
    s_add_u32 s36, s36, 17170432
    s_add_u32 s37, s36, 4096
    s_add_u32 s38, s36, 8192
    s_mov_b32 s50, 32768
    s_waitcnt lgkmcnt(0)
    v_min_u32 v5, 9, v1
    v_lshlrev_b32 v5, 10, v5
    s_cmp_lg_u32 s3, 0
    s_cbranch_scc1 L_f_p0
    s_barrier
    s_branch L_f_p1
L_f_p0:
    buffer_load_dword v6, v5, s[24:27], s36 offen sc1
    s_sub_u32 s50, s50, 1
    s_cbranch_scc1 L_f_p1o
    s_waitcnt vmcnt(0)
    v_and_b32 v6, 0xff, v6
    v_cmp_ne_u32 vcc, s52, v6
    s_cbranch_vccnz L_f_p0
L_f_p1:
    buffer_load_dwordx4 v[32:35], v10, s[24:27], s36 offen offset:0 sc1
    buffer_load_dwordx4 v[36:39], v10, s[24:27], s36 offen offset:1024 sc1
    buffer_load_dwordx4 v[40:43], v10, s[24:27], s36 offen offset:2048 sc1
    buffer_load_dwordx4 v[44:47], v10, s[24:27], s36 offen offset:3072 sc1
    buffer_load_dwordx4 v[48:51], v10, s[24:27], s37 offen offset:0 sc1
    buffer_load_dwordx4 v[52:55], v10, s[24:27], s37 offen offset:1024 sc1
    buffer_load_dwordx4 v[56:59], v10, s[24:27], s37 offen offset:2048 sc1
    buffer_load_dwordx4 v[60:63], v10, s[24:27], s37 offen offset:3072 sc1
    buffer_load_dwordx4 v[64:67], v10, s[24:27], s38 offen offset:0 sc1
    buffer_load_dwordx4 v[68:71], v10, s[24:27], s38 offen offset:1024 sc1
    v_mov_b32 v9, 0
    s_waitcnt vmcnt(9)
    v_xor_b32 v32, s52, v32
    v_xor_b32 v33, s53, v33
    v_xor_b32 v34, s54, v34
    v_xor_b32 v35, s55, v35
    v_or3_b32 v9, v9, v32, v33
    v_or3_b32 v9, v9, v34, v35
    s_waitcnt vmcnt(8)
    v_xor_b32 v36, s52, v36
    v_xor_b32 v37, s53, v37
    v_xor_b32 v38, s54, v38
    v_xor_b32 v39, s55, v39
    v_or3_b32 v9, v9, v36, v37
    v_or3_b32 v9, v9, v38, v39
    s_waitcnt vmcnt(7)
    v_xor_b32 v40, s52, v40
    v_xor_b32 v41, s53, v41
    v_xor_b32 v42, s54, v42
    v_xor_b32 v43, s55, v43
    v_or3_b32 v9, v9, v40, v41
    v_or3_b32 v9, v9, v42, v43
    s_waitcnt vmcnt(6)
    v_xor_b32 v44, s52, v44
    v_xor_b32 v45, s53, v45
    v_xor_b32 v46, s54, v46
    v_xor_b32 v47, s55, v47
    v_or3_b32 v9, v9, v44, v45
    v_or3_b32 v9, v9, v46, v47
    s_waitcnt vmcnt(5)
    v_xor_b32 v48, s52, v48
    v_xor_b32 v49, s53, v49
    v_xor_b32 v50, s54, v50
    v_xor_b32 v51, s55, v51
    v_or3_b32 v9, v9, v48, v49
    v_or3_b32 v9, v9, v50, v51
    s_waitcnt vmcnt(4)
    v_xor_b32 v52, s52, v52
    v_xor_b32 v53, s53, v53
    v_xor_b32 v54, s54, v54
    v_xor_b32 v55, s55, v55
    v_or3_b32 v9, v9, v52, v53
    v_or3_b32 v9, v9, v54, v55
    s_waitcnt vmcnt(3)
    v_xor_b32 v56, s52, v56
    v_xor_b32 v57, s53, v57
    v_xor_b32 v58, s54, v58
    v_xor_b32 v59, s55, v59
    v_or3_b32 v9, v9, v56, v57
    v_or3_b32 v9, v9, v58, v59
    s_waitcnt vmcnt(2)
    v_xor_b32 v60, s52, v60
    v_xor_b32 v61, s53, v61
    v_xor_b32 v62, s54, v62
    v_xor_b32 v63, s55, v63
    v_or3_b32 v9, v9, v60, v61
    v_or3_b32 v9, v9, v62, v63
    s_waitcnt vmcnt(1)
    v_xor_b32 v64, s52, v64
    v_xor_b32 v65, s53, v65
    v_xor_b32 v66, s54, v66
    v_xor_b32 v67, s55, v67
    v_or3_b32 v9, v9, v64, v65
    v_or3_b32 v9, v9, v66, v67
    s_waitcnt vmcnt(0)
    v_xor_b32 v68, s52, v68
    v_xor_b32 v69, s53, v69
    v_xor_b32 v70, s54, v70
    v_xor_b32 v71, s55, v71
    v_or3_b32 v9, v9, v68, v69
    v_or3_b32 v9, v9, v70, v71
    v_and_b32 v9, 0xff, v9
    v_cmp_ne_u32 vcc, 0, v9
    s_cbranch_vccnz L_f_p0
L_f_p1o:
    s_waitcnt vmcnt(0)
    ds_read_b64_tr_b16 v[128:129], v13 offset:16384
    ds_read_b64_tr_b16 v[130:131], v13 offset:16896
    ds_read_b64_tr_b16 v[132:133], v13 offset:20480
    ds_read_b64_tr_b16 v[134:135], v13 offset:20992
    ds_read_b64_tr_b16 v[136:137], v13 offset:16416
    ds_read_b64_tr_b16 v[138:139], v13 offset:16928
    ds_read_b64_tr_b16 v[140:141], v13 offset:20512
    ds_read_b64_tr_b16 v[142:143], v13 offset:21024
    s_waitcnt lgkmcnt(4)
    ds_read_b64_tr_b16 v[144:145], v13 offset:16448
    ds_read_b64_tr_b16 v[146:147], v13 offset:16960
    ds_read_b64_tr_b16 v[148:149], v13 offset:20544
    ds_read_b64_tr_b16 v[150:151], v13 offset:21056
    ds_read_b64_tr_b16 v[152:153], v13 offset:16480
    ds_read_b64_tr_b16 v[154:155], v13 offset:16992
    ds_read_b64_tr_b16 v[156:157], v13 offset:20576
    ds_read_b64_tr_b16 v[158:159], v13 offset:21088
    s_waitcnt lgkmcnt(4)
    s_waitcnt lgkmcnt(0)
    v_mov_b32 v9, 1
    s_mov_b64 exec, 1
    ds_add_u32 v30, v9 offset:52
    s_mov_b64 exec, -1
    v_pk_add_f32 v[32:33], v[32:33], v[36:37]
    v_pk_add_f32 v[34:35], v[34:35], v[38:39]
    v_pk_add_f32 v[32:33], v[32:33], v[40:41]
    v_pk_add_f32 v[34:35], v[34:35], v[42:43]
    v_pk_add_f32 v[32:33], v[32:33], v[44:45]
    v_pk_add_f32 v[34:35], v[34:35], v[46:47]
    v_pk_add_f32 v[32:33], v[32:33], v[48:49]
    v_pk_add_f32 v[34:35], v[34:35], v[50:51]
    v_pk_add_f32 v[32:33], v[32:33], v[52:53]
    v_pk_add_f32 v[34:35], v[34:35], v[54:55]
    v_pk_add_f32 v[32:33], v[32:33], v[56:57]
    v_pk_add_f32 v[34:35], v[34:35], v[58:59]
    v_pk_add_f32 v[32:33], v[32:33], v[60:61]
    v_pk_add_f32 v[34:35], v[34:35], v[62:63]
    v_pk_add_f32 v[32:33], v[32:33], v[64:65]
    v_pk_add_f32 v[34:35], v[34:35], v[66:67]
    v_pk_add_f32 v[32:33], v[32:33], v[68:69]
    v_pk_add_f32 v[34:35], v[34:35], v[70:71]
    v_mul_f32 v14, 0xbfb8aa3b, v32
    v_exp_f32 v14, v14
    s_nop 0
    v_add_f32 v14, 1.0, v14
    v_rcp_f32 v14, v14
    s_nop 0
    v_mul_f32 v14, v14, v32
    v_mul_f32 v14, v14, v34
    v_mul_f32 v15, 0xbfb8aa3b, v33
    v_exp_f32 v15, v15
    s_nop 0
    v_add_f32 v15, 1.0, v15
    v_rcp_f32 v15, v15
    s_nop 0
    v_mul_f32 v15, v15, v33
    v_mul_f32 v15, v15, v35
    v_cvt_pk_bf16_f32 v14, v14, v15
    v_lshl_add_u32 v6, v1, 1, v30
    ds_write_b16 v6, v14 offset:256
    ds_write_b16_d16_hi v6, v14 offset:384
    v_and_b32 v7, 1, v1
    v_lshl_add_u32 v7, v7, 7, v30
    v_lshl_add_u32 v7, v4, 4, v7
    s_waitcnt lgkmcnt(0)
    ds_read_b128 v[32:35], v7 offset:256
    ds_read_b128 v[36:39], v7 offset:320
    s_waitcnt lgkmcnt(0)
    v_mfma_f32_16x16x32_bf16 v[64:67], v[32:35], v[128:131], 0
    v_mfma_f32_16x16x32_bf16 v[64:67], v[36:39], v[132:135], v[64:67]
    v_mfma_f32_16x16x32_bf16 v[68:71], v[32:35], v[136:139], 0
    v_mfma_f32_16x16x32_bf16 v[68:71], v[36:39], v[140:143], v[68:71]
    v_mfma_f32_16x16x32_bf16 v[72:75], v[32:35], v[144:147], 0
    v_mfma_f32_16x16x32_bf16 v[72:75], v[36:39], v[148:151], v[72:75]
    v_mfma_f32_16x16x32_bf16 v[76:79], v[32:35], v[152:155], 0
    v_mfma_f32_16x16x32_bf16 v[76:79], v[36:39], v[156:159], v[76:79]
    s_lshl_b32 s36, s33, 8
    s_add_u32 s36, s36, 17694720
    s_add_u32 s37, s36, 61440
    s_nop 4
    v_cndmask_b32_e64 v96, v64, v68, s[44:45]
    v_cndmask_b32_e64 v96, v96, v72, s[46:47]
    v_cndmask_b32_e64 v96, v96, v76, s[48:49]
    v_and_or_b32 v96, v96, v21, v22
    buffer_store_dword v96, v23, s[24:27], s36 offen sc1
    v_cndmask_b32_e64 v97, v65, v69, s[44:45]
    v_cndmask_b32_e64 v97, v97, v73, s[46:47]
    v_cndmask_b32_e64 v97, v97, v77, s[48:49]
    v_and_or_b32 v97, v97, v21, v22
    buffer_store_dword v97, v23, s[24:27], s37 offen sc1
L_f_gather:
    s_and_b32 s36, s30, 3
    s_lshl_b32 s36, s36, 5
    s_lshl_b32 s37, s29, 8
    s_add_u32 s36, s36, s37
    s_xor_b32 s42, s42, s36
    s_xor_b32 s43, s43, s36
    s_and_b32 s42, s42, 0x760
    s_and_b32 s43, s43, 0x760
    s_min_u32 s36, s42, s43
    s_cmp_lg_u32 s36, 0
    s_cbranch_scc1 L_f_end
    s_lshr_b32 s32, s30, 2
    s_mul_i32 s40, s32, 320
    s_add_u32 s40, s40, 17694720
    s_andn2_b32 s36, s40, 255
    s_add_u32 s36, s36, 61440
    v_min_u32 v5, 47, v1
    v_lshrrev_b32 v6, 1, v5
    v_mul_u32_u24 v6, 2560, v6
    v_and_b32 v5, 1, v5
    v_lshl_add_u32 v5, v5, 8, v6
    v_min_u32 v7, 59, v1
    v_mul_u32_u24 v8, 3277, v7
    v_lshrrev_b32 v8, 16, v8
    v_mul_u32_u24 v6, 20, v8
    v_sub_u32 v6, v7, v6
    v_mul_u32_u24 v11, 20480, v8
    v_lshl_add_u32 v11, v6, 4, v11
    v_lshl_add_u32 v12, v7, 4, v30
    v_lshl_add_u32 v13, v6, 4, v30
    v_mov_b32 v20, v13
    v_mul_f32 v18, 0xbfb8aa3b, v18
    v_exp_f32 v18, v18
    s_nop 0
    v_add_f32 v18, 1.0, v18
    v_rcp_f32 v18, v18
    s_nop 0
    v_mul_f32 v19, 0xbfb8aa3b, v19
    v_exp_f32 v19, v19
    s_nop 0
    v_add_f32 v19, 1.0, v19
    v_rcp_f32 v19, v19
    s_nop 0
    s_mov_b32 s41, 0
    s_setprio 0
    s_mov_b32 s50, 262144
L_lw34:
    ds_read_b32 v9, v30 offset:32
    s_sub_u32 s50, s50, 1
    s_cbranch_scc1 L_lo35
    s_waitcnt lgkmcnt(0)
    v_cmp_gt_u32 vcc, 1, v9
    s_cbranch_vccnz L_lw34
L_lo35:
    s_setprio 3
    s_mov_b32 s50, 32768
    s_branch L_f_tok
L_f_y0:
    buffer_load_dword v6, v5, s[24:27], s36 offen sc1
    s_sub_u32 s50, s50, 1
    s_cbranch_scc1 L_f_yo
    s_waitcnt vmcnt(0)
    v_and_b32 v6, 0xff, v6
    v_cmp_ne_u32 vcc, s52, v6
    s_cbranch_vccnz L_f_y0
L_f_tok:
    s_cmp_lg_u32 s42, 0
    s_cbranch_scc1 L_f_next
    s_mov_b32 s37, s40
    buffer_load_dwordx4 v[32:35], v11, s[24:27], s37 offen sc1
    s_add_u32 s37, s37, 2560
    buffer_load_dwordx4 v[36:39], v11, s[24:27], s37 offen sc1
    s_add_u32 s37, s37, 2560
    buffer_load_dwordx4 v[40:43], v11, s[24:27], s37 offen sc1
    s_add_u32 s37, s37, 2560
    buffer_load_dwordx4 v[44:47], v11, s[24:27], s37 offen sc1
    s_add_u32 s37, s37, 2560
    buffer_load_dwordx4 v[48:51], v11, s[24:27], s37 offen sc1
    s_add_u32 s37, s37, 2560
    buffer_load_dwordx4 v[52:55], v11, s[24:27], s37 offen sc1
    s_add_u32 s37, s37, 2560
    buffer_load_dwordx4 v[56:59], v11, s[24:27], s37 offen sc1
    s_add_u32 s37, s37, 2560
    buffer_load_dwordx4 v[60:63], v11, s[24:27], s37 offen sc1
    s_add_u32 s37, s37, 2560
    s_setprio 3
    v_mov_b32 v9, 0
    s_waitcnt vmcnt(7)
    v_xor_b32 v32, s52, v32
    v_xor_b32 v33, s53, v33
    v_xor_b32 v34, s54, v34
    v_xor_b32 v35, s55, v35
    v_or3_b32 v9, v9, v32, v33
    v_or3_b32 v9, v9, v34, v35
    s_waitcnt vmcnt(6)
    v_xor_b32 v36, s52, v36
    v_xor_b32 v37, s53, v37
    v_xor_b32 v38, s54, v38
    v_xor_b32 v39, s55, v39
    v_or3_b32 v9, v9, v36, v37
    v_or3_b32 v9, v9, v38, v39
    s_waitcnt vmcnt(5)
    v_xor_b32 v40, s52, v40
    v_xor_b32 v41, s53, v41
    v_xor_b32 v42, s54, v42
    v_xor_b32 v43, s55, v43
    v_or3_b32 v9, v9, v40, v41
    v_or3_b32 v9, v9, v42, v43
    s_waitcnt vmcnt(4)
    v_xor_b32 v44, s52, v44
    v_xor_b32 v45, s53, v45
    v_xor_b32 v46, s54, v46
    v_xor_b32 v47, s55, v47
    v_or3_b32 v9, v9, v44, v45
    v_or3_b32 v9, v9, v46, v47
    s_waitcnt vmcnt(3)
    v_xor_b32 v48, s52, v48
    v_xor_b32 v49, s53, v49
    v_xor_b32 v50, s54, v50
    v_xor_b32 v51, s55, v51
    v_or3_b32 v9, v9, v48, v49
    v_or3_b32 v9, v9, v50, v51
    s_waitcnt vmcnt(2)
    v_xor_b32 v52, s52, v52
    v_xor_b32 v53, s53, v53
    v_xor_b32 v54, s54, v54
    v_xor_b32 v55, s55, v55
    v_or3_b32 v9, v9, v52, v53
    v_or3_b32 v9, v9, v54, v55
    s_waitcnt vmcnt(1)
    v_xor_b32 v56, s52, v56
    v_xor_b32 v57, s53, v57
    v_xor_b32 v58, s54, v58
    v_xor_b32 v59, s55, v59
    v_or3_b32 v9, v9, v56, v57
    v_or3_b32 v9, v9, v58, v59
    s_waitcnt vmcnt(0)
    v_xor_b32 v60, s52, v60
    v_xor_b32 v61, s53, v61
    v_xor_b32 v62, s54, v62
    v_xor_b32 v63, s55, v63
    v_or3_b32 v9, v9, v60, v61
    v_or3_b32 v9, v9, v62, v63
    v_and_b32 v9, 0xff, v9
    v_cmp_ne_u32 vcc, 0, v9
    s_cbranch_vccnz L_f_y0
    v_pk_add_f32 v[32:33], v[32:33], v[36:37]
    v_pk_add_f32 v[34:35], v[34:35], v[38:39]
    v_pk_add_f32 v[32:33], v[32:33], v[40:41]
    v_pk_add_f32 v[34:35], v[34:35], v[42:43]
    v_pk_add_f32 v[32:33], v[32:33], v[44:45]
    v_pk_add_f32 v[34:35], v[34:35], v[46:47]
    v_pk_add_f32 v[32:33], v[32:33], v[48:49]
    v_pk_add_f32 v[34:35], v[34:35], v[50:51]
    v_pk_add_f32 v[32:33], v[32:33], v[52:53]
    v_pk_add_f32 v[34:35], v[34:35], v[54:55]
    v_pk_add_f32 v[32:33], v[32:33], v[56:57]
    v_pk_add_f32 v[34:35], v[34:35], v[58:59]
    v_pk_add_f32 v[32:33], v[32:33], v[60:61]
    v_pk_add_f32 v[34:35], v[34:35], v[62:63]
    ds_write_b128 v12, v[32:35] offset:1152
    ds_read_b128 v[36:39], v20 offset:1152
    ds_read_b128 v[40:43], v20 offset:1472
    ds_read_b128 v[44:47], v20 offset:1792
    s_waitcnt lgkmcnt(0)
    v_pk_add_f32 v[36:37], v[36:37], v[40:41]
    v_pk_add_f32 v[36:37], v[36:37], v[44:45]
    v_pk_mul_f32 v[36:37], v[36:37], v[18:19] op_sel_hi:[1,0]
    v_pk_add_f32 v[38:39], v[38:39], v[42:43]
    v_pk_add_f32 v[38:39], v[38:39], v[46:47]
    v_pk_mul_f32 v[38:39], v[38:39], v[18:19] op_sel_hi:[1,0]
    ds_write_b128 v13, v[36:39] offset:512
L_f_next:
    s_mov_b32 s42, s43
    s_add_u32 s40, s40, 61440
    v_mov_b32 v18, v19
    v_add_u32 v13, 320, v13
    s_add_u32 s41, s41, 1
    s_cmp_lt_u32 s41, 2
    s_cbranch_scc1 L_f_tok
L_f_yo:
    s_waitcnt vmcnt(0)
    v_mov_b32 v9, 1
    s_mov_b64 exec, 1
    ds_add_u32 v30, v9 offset:36
    s_mov_b64 exec, -1
    s_waitcnt lgkmcnt(0)
L_f_end:
    s_waitcnt lgkmcnt(0)
    s_endpgm
L_rld:
    s_load_dwordx2 s[8:9], s[0:1], 16
    s_add_u32 s41, s40, 98304
    s_branch L_rld_issue
L_rld_loop:
    s_waitcnt vmcnt(12) lgkmcnt(0)
    s_barrier
L_rld_issue:
    s_lshl_b32 s36, s33, 7
    s_add_u32 s36, s36, s34
    s_add_u32 m0, s40, 0
    s_add_u32 s38, s36, 0
    buffer_load_dwordx4 v10, s[16:19], s38 offen  lds
    s_add_u32 m0, s40, 4096
    s_add_u32 s38, s36, 40960
    buffer_load_dwordx4 v10, s[16:19], s38 offen  lds
    s_add_u32 m0, s40, 8192
    s_add_u32 s38, s36, 81920
    buffer_load_dwordx4 v10, s[16:19], s38 offen  lds
    s_add_u32 m0, s40, 12288
    s_add_u32 s38, s36, 122880
    buffer_load_dwordx4 v10, s[16:19], s38 offen  lds
    s_and_b32 s33, s46, 15
    s_lshr_b64 s[46:47], s[46:47], 4
    s_add_u32 s33, s33, s48
    s_sub_u32 s36, s33, 10
    s_cselect_b32 s33, s33, s36
    s_add_u32 s40, s40, 16384
    s_cmp_eq_u32 s40, s41
    s_cselect_b32 s36, 98304, 0
    s_sub_u32 s40, s40, s36
    s_add_u32 s42, s42, 1
    s_cmp_lt_u32 s42, 4
    s_cbranch_scc1 L_rld_issue
    s_cmp_lt_u32 s42, 10
    s_cbranch_scc1 L_rld_loop
    s_mov_b32 s24, s12
    s_mov_b32 s25, s13
    s_mov_b32 s26, 19922944
    s_mov_b32 s27, 0x20000
    s_mov_b32 s20, s8
    s_mov_b32 s21, s9
    s_mov_b32 s22, 819200
    s_mov_b32 s23, 0x20000
    s_add_u32 s60, s60, 0x9e3779b9
    v_mov_b32 v30, 157440
    s_waitcnt vmcnt(12)
    s_barrier
    s_waitcnt vmcnt(8)
    s_barrier
    s_waitcnt vmcnt(4)
    s_barrier
    s_waitcnt vmcnt(0)
    s_barrier
    s_lshl_b32 s33, s29, 1
    s_add_u32 s33, s33, s31
    s_and_b32 s34, s28, 3
    s_mul_i32 s36, s33, 51200
    s_mul_i32 s37, s34, 320
    s_add_u32 s36, s36, s37
    s_mul_i32 s35, s34, 13440
    s_add_u32 s35, s35, 65536
    v_mul_u32_u24 v5, 3277, v1
    v_lshrrev_b32 v5, 16, v5
    v_mul_u32_u24 v6, 20, v5
    v_sub_u32 v6, v1, v6
    v_mul_u32_u24 v5, 1280, v5
    v_lshl_add_u32 v11, v6, 4, v5
    v_bfe_u32 v7, v1, 2, 2
    v_and_b32 v8, 3, v1
    v_lshl_add_u32 v8, v8, 3, s35
    v_lshrrev_b32 v5, 1, v4
    v_mul_u32_u24 v5, 20, v5
    v_and_b32 v6, 1, v4
    v_lshl_add_u32 v5, v6, 2, v5
    v_add_u32 v5, v5, v7
    v_mul_u32_u24 v5, 320, v5
    v_add_u32 v12, v5, v8
    v_mul_u32_u24 v5, 320, v7
    v_lshl_add_u32 v5, v4, 5, v5
    v_add_u32 v5, v5, v8
    s_bitcmp1_b32 s33, 1
    s_cselect_b32 s37, 0, 6400
    s_add_u32 s38, s37, 5120
    s_sub_u32 s37, 11520, s37
    v_add_u32 v13, s38, v5
    v_add_u32 v14, s37, v5
    v_lshlrev_b32 v10, 4, v1
    v_and_b32 v5, 15, v1
    v_lshlrev_b32 v5, 4, v5
    v_add_u32 v6, 0, v4
    v_cmp_lt_u32 s[44:45], 4, v6
    v_lshl_add_u32 v6, v6, 10, v5
    v_add_u32 v7, 97280, v6
    v_cndmask_b32_e64 v15, v6, v7, s[44:45]
    v_add_u32 v6, 4, v4
    v_cmp_lt_u32 s[44:45], 4, v6
    v_lshl_add_u32 v6, v6, 10, v5
    v_add_u32 v7, 97280, v6
    v_cndmask_b32_e64 v16, v6, v7, s[44:45]
    v_add_u32 v6, 8, v4
    v_cmp_lt_u32 s[44:45], 4, v6
    v_lshl_add_u32 v6, v6, 10, v5
    v_add_u32 v7, 97280, v6
    v_cndmask_b32_e64 v17, v6, v7, s[44:45]
    s_mul_i32 s40, s34, 204800
    s_add_u32 s40, s40, 18022400
    s_lshr_b32 s37, s33, 2
    s_add_u32 s37, s37, 16
    s_mul_i32 s41, s37, 5120
    s_add_u32 s41, s41, s40
    s_and_b32 s37, s33, 1
    s_lshl_b32 s37, s37, 9
    s_add_u32 s41, s41, s37
    s_and_b32 s37, s33, 2
    s_lshl_b32 s37, s37, 7
    s_add_u32 s41, s41, s37
    s_mul_i32 s37, s33, 5120
    s_add_u32 s40, s40, s37
    s_lshl_b32 s42, s33, 5
    s_add_u32 s42, s42, s34
    s_lshl_b32 s42, s42, 2
    s_add_u32 s42, s42, 17072128
    s_mov_b32 s50, 262144
L_lw36:
    ds_read_b32 v9, v30 offset:48
    s_sub_u32 s50, s50, 1
    s_cbranch_scc1 L_lo37
    s_waitcnt lgkmcnt(0)
    v_cmp_gt_u32 vcc, 4, v9
    s_cbranch_vccnz L_lw36
L_lo37:
    s_mov_b32 exec_hi, 0x0fffffff
    s_mov_b32 m0, s35
    s_add_u32 s37, s36, 0
    buffer_load_dwordx4 v11, s[20:23], s37 offen nt lds
    s_add_u32 m0, s35, 960
    s_add_u32 s37, s36, 3840
    buffer_load_dwordx4 v11, s[20:23], s37 offen nt lds
    s_add_u32 m0, s35, 1920
    s_add_u32 s37, s36, 7680
    buffer_load_dwordx4 v11, s[20:23], s37 offen nt lds
    s_add_u32 m0, s35, 2880
    s_add_u32 s37, s36, 11520
    buffer_load_dwordx4 v11, s[20:23], s37 offen nt lds
    s_add_u32 m0, s35, 3840
    s_add_u32 s37, s36, 15360
    buffer_load_dwordx4 v11, s[20:23], s37 offen nt lds
    s_add_u32 m0, s35, 4800
    s_add_u32 s37, s36, 19200
    buffer_load_dwordx4 v11, s[20:23], s37 offen nt lds
    s_add_u32 m0, s35, 5760
    s_add_u32 s37, s36, 23040
    buffer_load_dwordx4 v11, s[20:23], s37 offen nt lds
    s_add_u32 m0, s35, 6720
    s_add_u32 s37, s36, 26880
    buffer_load_dwordx4 v11, s[20:23], s37 offen nt lds
    s_add_u32 m0, s35, 7680
    s_add_u32 s37, s36, 30720
    buffer_load_dwordx4 v11, s[20:23], s37 offen nt lds
    s_add_u32 m0, s35, 8640
    s_add_u32 s37, s36, 34560
    buffer_load_dwordx4 v11, s[20:23], s37 offen nt lds
    s_add_u32 m0, s35, 9600
    s_add_u32 s37, s36, 38400
    buffer_load_dwordx4 v11, s[20:23], s37 offen nt lds
    s_add_u32 m0, s35, 10560
    s_add_u32 s37, s36, 42240
    buffer_load_dwordx4 v11, s[20:23], s37 offen nt lds
    s_add_u32 m0, s35, 11520
    s_add_u32 s37, s36, 46080
    buffer_load_dwordx4 v11, s[20:23], s37 offen nt lds
    s_add_u32 m0, s35, 12480
    s_mov_b64 exec, 0xfffff
    s_add_u32 s37, s36, 49920
    buffer_load_dwordx4 v11, s[20:23], s37 offen nt lds
    s_add_u32 m0, s35, 13440
    s_mov_b64 exec, -1
    s_waitcnt vmcnt(0)
    ds_read_b64_tr_b16 v[32:33], v12 offset:0
    ds_read_b64_tr_b16 v[34:35], v12 offset:2560
    ds_read_b64_tr_b16 v[36:37], v12 offset:32
    ds_read_b64_tr_b16 v[38:39], v12 offset:2592
    ds_read_b64_tr_b16 v[40:41], v12 offset:64
    ds_read_b64_tr_b16 v[42:43], v12 offset:2624
    ds_read_b64_tr_b16 v[44:45], v12 offset:96
    ds_read_b64_tr_b16 v[46:47], v12 offset:2656
    ds_read_b64_tr_b16 v[48:49], v12 offset:128
    ds_read_b64_tr_b16 v[50:51], v12 offset:2688
    s_waitcnt lgkmcnt(0)
    ds_read_b64_tr_b16 v[52:53], v12 offset:160
    ds_read_b64_tr_b16 v[54:55], v12 offset:2720
    ds_read_b64_tr_b16 v[56:57], v12 offset:192
    ds_read_b64_tr_b16 v[58:59], v12 offset:2752
    ds_read_b64_tr_b16 v[60:61], v12 offset:224
    ds_read_b64_tr_b16 v[62:63], v12 offset:2784
    ds_read_b64_tr_b16 v[64:65], v12 offset:256
    ds_read_b64_tr_b16 v[66:67], v12 offset:2816
    ds_read_b64_tr_b16 v[68:69], v12 offset:288
    ds_read_b64_tr_b16 v[70:71], v12 offset:2848
    s_waitcnt lgkmcnt(4)
    ds_read_b64_tr_b16 v[72:73], v13 offset:0
    ds_read_b64_tr_b16 v[74:75], v14 offset:0
    ds_read_b64_tr_b16 v[76:77], v13 offset:128
    ds_read_b64_tr_b16 v[78:79], v14 offset:128
    ds_read_b64_tr_b16 v[80:81], v13 offset:256
    ds_read_b64_tr_b16 v[82:83], v14 offset:256
    s_waitcnt lgkmcnt(0)
    s_add_u32 s37, s40, 0
    buffer_store_dwordx4 v[32:35], v10, s[24:27], s37 offen sc1
    s_add_u32 s37, s40, 1024
    buffer_store_dwordx4 v[36:39], v10, s[24:27], s37 offen sc1
    s_add_u32 s37, s40, 2048
    buffer_store_dwordx4 v[40:43], v10, s[24:27], s37 offen sc1
    s_add_u32 s37, s40, 3072
    buffer_store_dwordx4 v[44:47], v10, s[24:27], s37 offen sc1
    s_add_u32 s37, s40, 4096
    buffer_store_dwordx4 v[48:51], v10, s[24:27], s37 offen sc1
    s_add_u32 s37, s40, 102400
    buffer_store_dwordx4 v[52:55], v10, s[24:27], s37 offen sc1
    s_add_u32 s37, s40, 103424
    buffer_store_dwordx4 v[56:59], v10, s[24:27], s37 offen sc1
    s_add_u32 s37, s40, 104448
    buffer_store_dwordx4 v[60:63], v10, s[24:27], s37 offen sc1
    s_add_u32 s37, s40, 105472
    buffer_store_dwordx4 v[64:67], v10, s[24:27], s37 offen sc1
    s_add_u32 s37, s40, 106496
    buffer_store_dwordx4 v[68:71], v10, s[24:27], s37 offen sc1
    buffer_store_dwordx4 v[72:75], v15, s[24:27], s41 offen sc1
    buffer_store_dwordx4 v[76:79], v16, s[24:27], s41 offen sc1
    s_mov_b32 exec_hi, 0
    buffer_store_dwordx4 v[80:83], v17, s[24:27], s41 offen sc1
    s_mov_b64 exec, 1
    v_mov_b32 v5, s60
    s_waitcnt vmcnt(0)
    buffer_store_dword v5, off, s[24:27], s42 sc1
    s_mov_b64 exec, -1
    s_branch L_att_setup
L_router:
    s_mov_b32 s46, 0x76543210
    s_movk_i32 s47, 0x98
    s_lshl_b32 s36, s29, 2
    s_lshr_b32 s48, 0x1234567, s36
    s_and_b32 s48, s48, 15
    s_cmp_eq_u32 s32, 15
    s_cselect_b32 s46, 0x98765432, s46
    s_cselect_b32 s47, 0x10, s47
    s_and_b32 s33, s46, 15
    s_lshr_b64 s[46:47], s[46:47], 4
    s_add_u32 s33, s33, s48
    s_sub_u32 s36, s33, 10
    s_cselect_b32 s33, s33, s36
    v_and_b32 v5, 1, v1
    v_lshlrev_b32 v5, 11, v5
    v_lshl_add_u32 v14, v4, 4, v5
    v_add_u32 v14, 124416, v14
L_r_loop:
    s_barrier
    s_lshl_b32 s36, s33, 7
    v_add_u32 v15, s36, v14
    ds_read_b128 v[96:99], v15 offset:0
    ds_read_b128 v[100:103], v12
    ds_read_b128 v[104:107], v12 offset:2048
    ds_read_b128 v[108:111], v15 offset:64
    ds_read_b128 v[112:115], v13
    ds_read_b128 v[116:119], v13 offset:2048
    s_and_b32 s33, s46, 15
    s_lshr_b64 s[46:47], s[46:47], 4
    s_add_u32 s33, s33, s48
    s_sub_u32 s36, s33, 10
    s_cselect_b32 s33, s33, s36
    s_add_u32 s43, s43, 1
    s_cmp_eq_u32 s43, 6
    s_cselect_b32 s44, 0xfffec000, s45
    s_cselect_b32 s43, 0, s43
    v_add_u32 v12, s44, v12
    v_add_u32 v13, s44, v13
    s_waitcnt lgkmcnt(0)
    v_mfma_f32_16x16x32_bf16 v[32:35], v[96:99], v[100:103], v[32:35]
    v_mfma_f32_16x16x32_bf16 v[36:39], v[96:99], v[104:107], v[36:39]
    v_mfma_f32_16x16x32_bf16 v[32:35], v[108:111], v[112:115], v[32:35]
    v_mfma_f32_16x16x32_bf16 v[36:39], v[108:111], v[116:119], v[36:39]
    s_add_u32 s42, s42, 1
    s_cmp_lt_u32 s42, 10
    s_cbranch_scc1 L_r_loop
    s_nop 1
    s_lshl_b32 s36, s29, 8
    s_lshl_b32 s37, s31, 7
    s_add_u32 s36, s36, s37
    s_lshl_b32 s37, s28, 5
    s_add_u32 s36, s36, s37
    s_mov_b32 s37, 16777216
    v_add3_u32 v14, s36, v3, 0
    v_cvt_pk_bf16_f32 v26, v32, v33
    v_lshlrev_b32 v21, 16, v26
    v_ashrrev_i32 v24, 31, v21
    v_or_b32 v24, 0x80000000, v24
    v_xor_b32 v21, v21, v24
    v_and_b32 v21, 0xffff0000, v21
    v_sub_u32 v24, 0xffff, v14
    v_or_b32 v21, v21, v24
    v_add3_u32 v15, s36, v3, 16
    v_cvt_pk_bf16_f32 v27, v36, v37
    v_lshlrev_b32 v22, 16, v27
    v_ashrrev_i32 v24, 31, v22
    v_or_b32 v24, 0x80000000, v24
    v_xor_b32 v22, v22, v24
    v_and_b32 v22, 0xffff0000, v22
    v_sub_u32 v24, 0xffff, v15
    v_or_b32 v22, v22, v24
    v_max_u32 v25, v21, v22
    s_nop 1
    v_max_u32_dpp v25, v25, v25 row_shr:1 row_mask:0xf bank_mask:0xf bound_ctrl:1
    s_nop 1
    v_max_u32_dpp v25, v25, v25 row_shr:2 row_mask:0xf bank_mask:0xf bound_ctrl:1
    s_nop 1
    v_max_u32_dpp v25, v25, v25 row_shr:4 row_mask:0xf bank_mask:0xf bound_ctrl:1
    s_nop 1
    v_max_u32_dpp v25, v25, v25 row_shr:8 row_mask:0xf bank_mask:0xf bound_ctrl:1
    s_nop 0
    v_readlane_b32 s46, v25, 63
    s_nop 1
    v_cmp_ne_u32 s[48:49], s46, v21
    s_nop 1
    v_cndmask_b32_e64 v21, 0, v21, s[48:49]
    v_cmp_ne_u32 s[48:49], s46, v22
    s_nop 1
    v_cndmask_b32_e64 v22, 0, v22, s[48:49]
    v_max_u32 v25, v21, v22
    s_nop 1
    v_max_u32_dpp v25, v25, v25 row_shr:1 row_mask:0xf bank_mask:0xf bound_ctrl:1
    s_nop 1
    v_max_u32_dpp v25, v25, v25 row_shr:2 row_mask:0xf bank_mask:0xf bound_ctrl:1
    s_nop 1
    v_max_u32_dpp v25, v25, v25 row_shr:4 row_mask:0xf bank_mask:0xf bound_ctrl:1
    s_nop 1
    v_max_u32_dpp v25, v25, v25 row_shr:8 row_mask:0xf bank_mask:0xf bound_ctrl:1
    s_nop 0
    v_readlane_b32 s47, v25, 63
    s_lshr_b32 s36, s36, 1
    s_add_u32 s36, s36, 16842752
    v_mov_b32 v28, s46
    v_mov_b32 v29, s60
    v_mov_b32 v30, s47
    v_mov_b32 v31, s60
    s_mov_b64 exec, 1
    buffer_store_dwordx4 v[28:31], off, s[24:27], s36 sc1
    v_mov_b32 v9, 1
    ds_add_u32 v19, v9 offset:48
    s_mov_b64 exec, 0xffff
    v_and_b32 v23, 0xffff0000, v26
    v_mul_f32 v23, 0xbfb8aa3b, v23
    v_exp_f32 v23, v23
    s_nop 0
    v_add_f32 v23, 1.0, v23
    v_rcp_f32 v23, v23
    s_nop 0
    v_cvt_pk_bf16_f32 v23, v23, v23
    v_and_b32 v26, 0xffff0000, v23
    v_lshlrev_b32 v24, 2, v14
    buffer_store_dword v26, v24, s[24:27], s37 offen sc1
    v_and_b32 v23, 0xffff0000, v27
    v_mul_f32 v23, 0xbfb8aa3b, v23
    v_exp_f32 v23, v23
    s_nop 0
    v_add_f32 v23, 1.0, v23
    v_rcp_f32 v23, v23
    s_nop 0
    v_cvt_pk_bf16_f32 v23, v23, v23
    v_and_b32 v27, 0xffff0000, v23
    v_lshlrev_b32 v24, 2, v15
    buffer_store_dword v27, v24, s[24:27], s37 offen sc1
    s_mov_b64 exec, 1
    s_lshl_b32 s36, s29, 5
    s_add_u32 s36, s36, s30
    s_lshl_b32 s36, s36, 2
    s_add_u32 s36, s36, s28
    s_lshl_b32 s36, s36, 2
    s_add_u32 s36, s36, 16973824
    v_mov_b32 v9, 1
    s_waitcnt vmcnt(0)
    buffer_store_dword v29, off, s[24:27], s36 sc1
    ds_add_u32 v19, v9 offset:40
    s_mov_b64 exec, -1
    v_mov_b32 v30, 157440
    s_mov_b32 s50, 262144
L_lw38:
    ds_read_b32 v9, v30 offset:12
    s_sub_u32 s50, s50, 1
    s_cbranch_scc1 L_lo39
    s_waitcnt lgkmcnt(0)
    v_cmp_gt_u32 vcc, 1, v9
    s_cbranch_vccnz L_lw38
L_lo39:
    s_branch L_att_setup
L_hw0:
    s_cmp_eq_u32 s33, 0
    s_cselect_b32 s36, 1, 2
    s_mov_b32 s50, 262144
L_hs0:
    ds_read_b32 v9, v30 offset:4
    s_sub_u32 s50, s50, 1
    s_cbranch_scc1 L_hr0
    s_waitcnt lgkmcnt(0)
    v_cmp_gt_u32 vcc, s36, v9
    s_cbranch_vccnz L_hs0
    s_branch L_hr0
L_hw1:
    s_cmp_eq_u32 s33, 1
    s_cselect_b32 s36, 1, 2
    s_mov_b32 s50, 262144
L_hs1:
    ds_read_b32 v9, v30 offset:4
    s_sub_u32 s50, s50, 1
    s_cbranch_scc1 L_hr1
    s_waitcnt lgkmcnt(0)
    v_cmp_gt_u32 vcc, s36, v9
    s_cbranch_vccnz L_hs1
    s_branch L_hr1
L_hw2:
    s_cmp_eq_u32 s29, 0
    s_cbranch_scc1 L_att_fin
    s_cmp_eq_u32 s33, 2
    s_cselect_b32 s36, 1, 2
    s_mov_b32 s50, 262144
L_hs2:
    ds_read_b32 v9, v30 offset:4
    s_sub_u32 s50, s50, 1
    s_cbranch_scc1 L_hr2
    s_waitcnt lgkmcnt(0)
    v_cmp_gt_u32 vcc, s36, v9
    s_cbranch_vccnz L_hs2
    s_branch L_hr2
L_hw3:
    s_cmp_eq_u32 s29, 0
    s_cbranch_scc1 L_att_fin
    s_cmp_eq_u32 s33, 3
    s_cselect_b32 s36, 1, 2
    s_mov_b32 s50, 262144
L_hs3:
    ds_read_b32 v9, v30 offset:4
    s_sub_u32 s50, s50, 1
    s_cbranch_scc1 L_hr3
    s_waitcnt lgkmcnt(0)
    v_cmp_gt_u32 vcc, s36, v9
    s_cbranch_vccnz L_hs3
    s_branch L_hr3
L_hw4:
    s_cmp_eq_u32 s29, 0
    s_cbranch_scc1 L_att_fin
    s_cmp_eq_u32 s33, 4
    s_cselect_b32 s36, 1, 2
    s_mov_b32 s50, 262144
L_hs4:
    ds_read_b32 v9, v30 offset:4
    s_sub_u32 s50, s50, 1
    s_cbranch_scc1 L_hr4
    s_waitcnt lgkmcnt(0)
    v_cmp_gt_u32 vcc, s36, v9
    s_cbranch_vccnz L_hs4
    s_branch L_hr4
L_hw5:
    s_cmp_eq_u32 s29, 0
    s_cbranch_scc1 L_att_fin
    s_cmp_eq_u32 s33, 5
    s_cselect_b32 s36, 1, 2
    s_mov_b32 s50, 262144
L_hs5:
    ds_read_b32 v9, v30 offset:4
    s_sub_u32 s50, s50, 1
    s_cbranch_scc1 L_hr5
    s_waitcnt lgkmcnt(0)
    v_cmp_gt_u32 vcc, s36, v9
    s_cbranch_vccnz L_hs5
    s_branch L_hr5
L_hw6:
    s_cmp_eq_u32 s29, 0
    s_cbranch_scc1 L_att_fin
    s_cmp_eq_u32 s33, 6
    s_cselect_b32 s36, 1, 2
    s_mov_b32 s50, 262144
L_hs6:
    ds_read_b32 v9, v30 offset:4
    s_sub_u32 s50, s50, 1
    s_cbranch_scc1 L_hr6
    s_waitcnt lgkmcnt(0)
    v_cmp_gt_u32 vcc, s36, v9
    s_cbranch_vccnz L_hs6
    s_branch L_hr6
L_hw7:
    s_cmp_eq_u32 s29, 0
    s_cbranch_scc1 L_att_fin
    s_cmp_eq_u32 s33, 7
    s_cselect_b32 s36, 1, 2
    s_mov_b32 s50, 262144
L_hs7:
    ds_read_b32 v9, v30 offset:4
    s_sub_u32 s50, s50, 1
    s_cbranch_scc1 L_hr7
    s_waitcnt lgkmcnt(0)
    v_cmp_gt_u32 vcc, s36, v9
    s_cbranch_vccnz L_hs7
    s_branch L_hr7
L_hw8:
    s_branch L_att_fin
L_hw9:
    s_branch L_att_fin
L_fallback:
    s_cmp_lg_u32 s40, 0
    s_cbranch_scc1 L_att_ok
    s_mov_b32 s40, 1
    v_lshlrev_b32 v6, 2, v4
    v_sub_u32 v6, v3, v6
    v_mov_b32 v7, 0xff800000
    v_cmp_le_i32 s[44:45], 0, v6
    v_cmp_le_i32 s[48:49], 1, v6
    s_nop 0
    v_cndmask_b32_e64 v64, v7, 0, s[44:45]
    v_cndmask_b32_e64 v65, v7, 0, s[48:49]
    v_cmp_le_i32 s[44:45], 2, v6
    v_cmp_le_i32 s[48:49], 3, v6
    s_nop 0
    v_cndmask_b32_e64 v66, v7, 0, s[44:45]
    v_cndmask_b32_e64 v67, v7, 0, s[48:49]
    v_cmp_le_i32 s[44:45], 8, v6
    v_cmp_le_i32 s[48:49], 9, v6
    s_nop 0
    v_cndmask_b32_e64 v68, v7, 0, s[44:45]
    v_cndmask_b32_e64 v69, v7, 0, s[48:49]
    v_cmp_le_i32 s[44:45], 10, v6
    v_cmp_le_i32 s[48:49], 11, v6
    s_nop 0
    v_cndmask_b32_e64 v70, v7, 0, s[44:45]
    v_cndmask_b32_e64 v71, v7, 0, s[48:49]
    v_cmp_le_i32 s[44:45], 16, v6
    v_cmp_le_i32 s[48:49], 17, v6
    s_nop 0
    v_cndmask_b32_e64 v72, v7, 0, s[44:45]
    v_cndmask_b32_e64 v73, v7, 0, s[48:49]
    v_cmp_le_i32 s[44:45], 18, v6
    v_cmp_le_i32 s[48:49], 19, v6
    s_nop 0
    v_cndmask_b32_e64 v74, v7, 0, s[44:45]
    v_cndmask_b32_e64 v75, v7, 0, s[48:49]
    v_cmp_le_i32 s[44:45], 24, v6
    v_cmp_le_i32 s[48:49], 25, v6
    s_nop 0
    v_cndmask_b32_e64 v76, v7, 0, s[44:45]
    v_cndmask_b32_e64 v77, v7, 0, s[48:49]
    v_cmp_le_i32 s[44:45], 26, v6
    v_cmp_le_i32 s[48:49], 27, v6
    s_nop 0
    v_cndmask_b32_e64 v78, v7, 0, s[44:45]
    v_cndmask_b32_e64 v79, v7, 0, s[48:49]
    v_mov_b32 v8, 0xff800000
    v_add_u32 v5, 4096, v12
    v_add_u32 v6, 4096, v13
    s_mov_b32 s36, 0
L_fb_loop:
    ds_read_b128 v[40:43], v5
    ds_read_b64 v[38:39], v6
    v_subrev_u32 v5, 512, v5
    v_subrev_u32 v6, 512, v6
    s_waitcnt lgkmcnt(0)
    s_cmp_eq_u32 s36, 0
    s_cbranch_scc1 L_fb_a
    s_cmp_eq_u32 s36, 8
    s_cbranch_scc1 L_fb_b
    v_mfma_f32_32x32x16_bf16 v[80:95], v[40:43], v[32:35], 0
    s_branch L_fb_c
L_fb_a:
    v_mfma_f32_32x32x16_bf16 v[80:95], v[40:43], v[32:35], v[64:79]
    s_branch L_fb_c
L_fb_b:
    v_mfma_f32_32x32x16_bf16 v[80:95], v[40:43], v[32:35], v[112:127]
L_fb_c:
    v_mfma_f32_32x32x8_bf16 v[80:95], v[38:39], v[36:37], v[80:95]
    s_nop 11
    v_max3_f32 v8, v8, v80, v81
    v_max3_f32 v8, v8, v82, v83
    v_max3_f32 v8, v8, v84, v85
    v_max3_f32 v8, v8, v86, v87
    v_max3_f32 v8, v8, v88, v89
    v_max3_f32 v8, v8, v90, v91
    v_max3_f32 v8, v8, v92, v93
    v_max3_f32 v8, v8, v94, v95
    s_add_u32 s36, s36, 1
    s_cmp_lt_u32 s36, s34
    s_cbranch_scc1 L_fb_loop
    v_mov_b32 v9, v8
    s_nop 1
    v_permlane32_swap_b32 v8, v9
    v_max_f32 v8, v8, v9
    v_sub_f32 v8, 0, v8
    v_and_b32 v5, 0xffff0000, v8
    v_sub_f32 v8, v8, v5
    v_and_b32 v6, 0xffff0000, v8
    v_sub_f32 v8, v8, v6
    v_lshrrev_b32 v5, 16, v5
    v_or_b32 v5, v5, v6
    v_lshrrev_b32 v8, 16, v8
    v_cmp_eq_u32 s[44:45], 0, v4
    s_nop 1
    v_cndmask_b32_e64 v36, v5, v36, s[44:45]
    v_cndmask_b32_e64 v37, v8, v37, s[44:45]
    s_branch L_att_go
L_q_far:
    v_mfma_f32_16x16x32_bf16 v[32:35], v[128:131], v[144:147], v[32:35]
    v_mfma_f32_16x16x32_bf16 v[48:51], v[132:135], v[144:147], v[48:51]
    s_nop 1
    v_mfma_f32_16x16x32_bf16 v[64:67], v[104:107], v[112:115], v[64:67]
    s_nop 1
    v_mfma_f32_16x16x32_bf16 v[80:83], v[108:111], v[112:115], v[80:83]
    s_nop 1
    v_mfma_f32_16x16x32_bf16 v[36:39], v[128:131], v[148:151], v[36:39]
    v_pk_mul_f32 v[32:33], v[32:33], s[38:39]
    v_pk_mul_f32 v[34:35], v[34:35], s[38:39]
    v_pk_mul_f32 v[48:49], v[48:49], s[38:39]
    v_mfma_f32_16x16x32_bf16 v[52:55], v[132:135], v[148:151], v[52:55]
    v_pk_mul_f32 v[50:51], v[50:51], s[38:39]
    v_cvt_pk_bf16_f32 v32, v32, v33
    v_cvt_pk_bf16_f32 v33, v34, v35
    v_mfma_f32_16x16x32_bf16 v[68:71], v[104:107], v[116:119], v[68:71]
    v_cvt_pk_bf16_f32 v34, v48, v49
    v_cvt_pk_bf16_f32 v35, v50, v51
    buffer_store_dwordx4 v[32:35], v18, s[24:27], s34 offen offset:0 sc1
    v_mfma_f32_16x16x32_bf16 v[84:87], v[108:111], v[116:119], v[84:87]
    v_pk_mul_f32 v[36:37], v[36:37], s[38:39]
    v_pk_mul_f32 v[38:39], v[38:39], s[38:39]
    v_pk_mul_f32 v[52:53], v[52:53], s[38:39]
    v_mfma_f32_16x16x32_bf16 v[40:43], v[128:131], v[152:155], v[40:43]
    v_pk_mul_f32 v[54:55], v[54:55], s[38:39]
    v_cvt_pk_bf16_f32 v36, v36, v37
    v_cvt_pk_bf16_f32 v37, v38, v39
    v_mfma_f32_16x16x32_bf16 v[56:59], v[132:135], v[152:155], v[56:59]
    v_cvt_pk_bf16_f32 v38, v52, v53
    v_cvt_pk_bf16_f32 v39, v54, v55
    buffer_store_dwordx4 v[36:39], v18, s[24:27], s34 offen offset:256 sc1
    v_mfma_f32_16x16x32_bf16 v[72:75], v[104:107], v[120:123], v[72:75]
    s_nop 1
    v_mfma_f32_16x16x32_bf16 v[88:91], v[108:111], v[120:123], v[88:91]
    s_nop 0
    v_mfma_f32_16x16x32_bf16 v[44:47], v[128:131], v[156:159], v[44:47]
    v_pk_mul_f32 v[40:41], v[40:41], s[38:39]
    v_pk_mul_f32 v[42:43], v[42:43], s[38:39]
    v_pk_mul_f32 v[56:57], v[56:57], s[38:39]
    v_mfma_f32_16x16x32_bf16 v[60:63], v[132:135], v[156:159], v[60:63]
    v_pk_mul_f32 v[58:59], v[58:59], s[38:39]
    v_cvt_pk_bf16_f32 v40, v40, v41
    v_cvt_pk_bf16_f32 v41, v42, v43
    v_mfma_f32_16x16x32_bf16 v[76:79], v[104:107], v[124:127], v[76:79]
    v_cvt_pk_bf16_f32 v42, v56, v57
    v_cvt_pk_bf16_f32 v43, v58, v59
    buffer_store_dwordx4 v[40:43], v18, s[24:27], s34 offen offset:512 sc1
    v_mfma_f32_16x16x32_bf16 v[92:95], v[108:111], v[124:127], v[92:95]
    v_pk_mul_f32 v[44:45], v[44:45], s[38:39]
    v_pk_mul_f32 v[46:47], v[46:47], s[38:39]
    v_pk_mul_f32 v[60:61], v[60:61], s[38:39]
    s_waitcnt lgkmcnt(0)
    v_mfma_f32_16x16x32_bf16 v[64:67], v[136:139], v[144:147], v[64:67]
    v_pk_mul_f32 v[62:63], v[62:63], s[38:39]
    v_cvt_pk_bf16_f32 v44, v44, v45
    v_cvt_pk_bf16_f32 v45, v46, v47
    v_mfma_f32_16x16x32_bf16 v[80:83], v[140:143], v[144:147], v[80:83]
    v_cvt_pk_bf16_f32 v46, v60, v61
    v_cvt_pk_bf16_f32 v47, v62, v63
    buffer_store_dwordx4 v[44:47], v18, s[24:27], s34 offen offset:768 sc1
    v_mfma_f32_16x16x32_bf16 v[68:71], v[136:139], v[148:151], v[68:71]
    s_nop 1
    v_mfma_f32_16x16x32_bf16 v[84:87], v[140:143], v[148:151], v[84:87]
    s_nop 0
    v_mfma_f32_16x16x32_bf16 v[72:75], v[136:139], v[152:155], v[72:75]
    v_pk_mul_f32 v[64:65], v[64:65], s[38:39]
    v_pk_mul_f32 v[66:67], v[66:67], s[38:39]
    v_pk_mul_f32 v[80:81], v[80:81], s[38:39]
    v_mfma_f32_16x16x32_bf16 v[88:91], v[140:143], v[152:155], v[88:91]
    v_pk_mul_f32 v[82:83], v[82:83], s[38:39]
    v_cvt_pk_bf16_f32 v64, v64, v65
    v_cvt_pk_bf16_f32 v65, v66, v67
    v_mfma_f32_16x16x32_bf16 v[76:79], v[136:139], v[156:159], v[76:79]
    v_cvt_pk_bf16_f32 v66, v80, v81
    v_cvt_pk_bf16_f32 v67, v82, v83
    buffer_store_dwordx4 v[64:67], v18, s[24:27], s35 offen offset:0 sc1
    v_mfma_f32_16x16x32_bf16 v[92:95], v[140:143], v[156:159], v[92:95]
    v_pk_mul_f32 v[68:69], v[68:69], s[38:39]
    v_pk_mul_f32 v[70:71], v[70:71], s[38:39]
    v_pk_mul_f32 v[84:85], v[84:85], s[38:39]
    v_pk_mul_f32 v[86:87], v[86:87], s[38:39]
    v_cvt_pk_bf16_f32 v68, v68, v69
    v_cvt_pk_bf16_f32 v69, v70, v71
    v_cvt_pk_bf16_f32 v70, v84, v85
    v_cvt_pk_bf16_f32 v71, v86, v87
    buffer_store_dwordx4 v[68:71], v18, s[24:27], s35 offen offset:256 sc1
    v_pk_mul_f32 v[72:73], v[72:73], s[38:39]
    v_pk_mul_f32 v[74:75], v[74:75], s[38:39]
    v_pk_mul_f32 v[88:89], v[88:89], s[38:39]
    v_pk_mul_f32 v[90:91], v[90:91], s[38:39]
    v_cvt_pk_bf16_f32 v72, v72, v73
    v_cvt_pk_bf16_f32 v73, v74, v75
    v_cvt_pk_bf16_f32 v74, v88, v89
    v_cvt_pk_bf16_f32 v75, v90, v91
    buffer_store_dwordx4 v[72:75], v18, s[24:27], s35 offen offset:512 sc1
    v_pk_mul_f32 v[76:77], v[76:77], s[38:39]
    v_pk_mul_f32 v[78:79], v[78:79], s[38:39]
    v_pk_mul_f32 v[92:93], v[92:93], s[38:39]
    v_pk_mul_f32 v[94:95], v[94:95], s[38:39]
    v_cvt_pk_bf16_f32 v76, v76, v77
    v_cvt_pk_bf16_f32 v77, v78, v79
    v_cvt_pk_bf16_f32 v78, v92, v93
    v_cvt_pk_bf16_f32 v79, v94, v95
    buffer_store_dwordx4 v[76:79], v18, s[24:27], s35 offen offset:768 sc1
    s_branch L_g_end
L_exit:
    s_endpgm
L_code_end:
.section .rodata,"a"
.p2align 6
.amdhsa_kernel gated_mix__sliding_block__moe_arch_mod__prompt_kernel
  .amdhsa_next_free_vgpr 168
  .amdhsa_next_free_sgpr 96
  .amdhsa_accum_offset 168
  .amdhsa_group_segment_fixed_size 0
  .amdhsa_kernarg_size 96
  .amdhsa_user_sgpr_count 2
  .amdhsa_user_sgpr_kernarg_segment_ptr 1
  .amdhsa_system_sgpr_workgroup_id_x 1
.end_amdhsa_kernel
```
